```python
import torch

def _softmax(x, axis=-1):
    return torch.softmax(x, dim=axis)
def _gelu(x):
    return torch.nn.functional.gelu(x, approximate="tanh")
def _silu(x):
    return torch.nn.functional.silu(x)
def _sigmoid(x):
    return torch.sigmoid(x)
def _layernorm(x, axis=-1, eps=1e-5):
    m = x.mean(dim=axis, keepdim=True)
    v = x.var(dim=axis, keepdim=True, unbiased=False)
    return (x - m) / torch.sqrt(v + eps)
def _scatter_add(tgt, idx, src, axis=0):
    return tgt.clone().index_add_(axis, idx, src)
def _segment_sum(src, seg, n):
    out = torch.zeros((n,) + src.shape[1:], dtype=src.dtype)
    return out.index_add_(0, seg, src)
def _pad(x, pw):
    flat = tuple(v for pair in reversed(pw) for v in pair)
    return torch.nn.functional.pad(x, flat)

kernel_name = 'standalone__edge_featured_mpnn_gatedgcn__graph'

def setup_inputs():

    _w = (lambda a: (lambda t: t.to(torch.bfloat16) if t.is_floating_point() else t)(torch.as_tensor(a)))
    N, deg, D, De = 10000, 16, 256, max(16, 1)
    E = N * deg
    return {
        "x": _w((lambda *s: torch.randn(*s, dtype=torch.bfloat16) * 0.4)(N, D)),
        "e_attr": _w((lambda *s: torch.randn(*s, dtype=torch.bfloat16) * 0.4)(E, De)),
        "src": _w((lambda lo, hi, *s: torch.randint(lo, hi, s))(0, N, E).to(torch.int64)),
        "dst": _w((lambda lo, hi, *s: torch.randint(lo, hi, s))(0, N, E).to(torch.int64)),
        "w_a": _w((lambda *s: torch.randn(*s, dtype=torch.bfloat16) * 0.4)(D, D)),
        "w_b": _w((lambda *s: torch.randn(*s, dtype=torch.bfloat16) * 0.4)(D, D)),
        "w_c": _w((lambda *s: torch.randn(*s, dtype=torch.bfloat16) * 0.4)(De, D)),
        "w_u": _w((lambda *s: torch.randn(*s, dtype=torch.bfloat16) * 0.05)(D, D)),
        "w_v": _w((lambda *s: torch.randn(*s, dtype=torch.bfloat16) * 0.05)(D, D)),
    }

def reference(x, e_attr, src, dst, w_a, w_b, w_c, w_u, w_v):
    N, D = x.shape
    hv = x @ w_v
    g = x[dst] @ w_a + x[src] @ w_b + e_attr @ w_c
    eta = _sigmoid(g)
    denom = _segment_sum(eta, dst, N) + 1e-6
    eta_n = eta / denom[dst]
    agg = _segment_sum(eta_n * hv[src], dst, N)
    z = x @ w_u + agg
    relu_z = torch.where(z > 0, z, 0 * z)
    return x + relu_z
```

```asm
; @launch grid=(256,1,1) block=(512,1,1) lds=161664
.amdgcn_target "amdgcn-amd-amdhsa--gfx950"
.text
.globl standalone__edge_featured_mpnn_gatedgcn__graph_kernel
.p2align 8
.type standalone__edge_featured_mpnn_gatedgcn__graph_kernel,@function
standalone__edge_featured_mpnn_gatedgcn__graph_kernel:
KSTART:
    s_cmp_ge_u32 s2, 256
    s_cbranch_scc1 .Lexit
    s_cmp_ge_u32 s2, 16
    s_cbranch_scc1 .L1
    s_getpc_b64 s[8:9]
.L2:
    s_sub_u32 s8, s8, .L2-KSTART
    s_subb_u32 s9, s9, 0
    v_lshlrev_b32 v4, 4, v0
    global_load_dwordx4 v[192:195], v4, s[8:9]
    v_add_u32 v5, 0x2000, v4
    global_load_dwordx4 v[192:195], v5, s[8:9]
    v_add_u32 v5, 0x4000, v4
    global_load_dwordx4 v[192:195], v5, s[8:9]
    v_add_u32 v5, ((.Lexit-KSTART-8192+64) & 0xffffff00), v4
    global_load_dwordx4 v[192:195], v5, s[8:9]
.L1:
    s_load_dwordx16 s[16:31], s[0:1], 0
    s_load_dwordx8 s[32:39], s[0:1], 64
    s_lshr_b32 s76, s2, 2
    s_and_b32 s77, s2, 3
    v_and_b32 v1, 63, v0
    v_lshrrev_b32 v4, 6, v0
    v_lshrrev_b32 v2, 4, v1
    v_readfirstlane_b32 s78, v4
    v_and_b32 v3, 15, v1
    v_lshlrev_b32 v12, 4, v3
    v_lshlrev_b32 v13, 3, v2
    v_and_b32 v14, 3, v1
    s_and_b32 s79, s78, 3
    s_lshr_b32 s80, s78, 2
    s_mul_i32 s3, s80, 80
    v_add_u32 v15, s3, v3
    s_cmp_eq_u32 s76, 63
    s_movk_i32 s81, 157
    s_cselect_b32 s81, 109, s81
    s_mov_b32 s91, 0x00003f80
    s_mov_b32 s92, 0x3f800000
    s_mov_b32 s94, 0x3f800000
    s_mov_b32 s95, 0x3f800000
    s_mov_b32 s87, 0
    s_mov_b32 s85, 0
    s_mov_b32 s88, 1
    s_mov_b32 s89, 1
    s_brev_b32 s97, 1
    s_mul_i32 s99, s76, 157
    s_waitcnt lgkmcnt(0)
    s_mov_b32 s40, s16
    s_and_b32 s41, s17, 0xffff
    s_mov_b32 s42, 5120000
    s_mov_b32 s43, 0x20000
    s_mov_b32 s44, s18
    s_and_b32 s45, s19, 0xffff
    s_mov_b32 s46, 5120000
    s_mov_b32 s47, 0x20000
    s_mul_i32 s3, s77, 2621440
    s_add_u32 s48, s38, s3
    s_addc_u32 s49, s39, 0
    s_and_b32 s49, s49, 0xffff
    s_mov_b32 s50, 2576384
    s_mov_b32 s51, 0x20000
    s_add_u32 s52, s38, 10485760
    s_addc_u32 s53, s39, 0
    s_and_b32 s53, s53, 0xffff
    s_mov_b32 s54, 2097152
    s_mov_b32 s55, 0x20000
    s_add_u32 s56, s38, 18874368
    s_addc_u32 s57, s39, 0
    s_mov_b32 s60, s34
    s_and_b32 s61, s35, 0xffff
    s_mov_b32 s62, 5120000
    s_mov_b32 s63, 0x20000
    s_cmp_lt_u32 s78, 4
    s_cbranch_scc1 .L4
    v_mov_b32 v60, 0
    v_mov_b32 v61, 0
    v_mov_b32 v62, 0
    v_mov_b32 v63, 0
    s_sub_u32 s3, s78, 4
    s_lshl_b32 s3, s3, 11
    s_add_u32 s3, s3, 147968
    v_lshl_add_u32 v4, v1, 4, s3
    ds_write_b128 v4, v[60:63]
    ds_write_b128 v4, v[60:63] offset:1024
    s_cmp_lg_u32 s78, 4
    s_cbranch_scc1 .L5
    v_lshlrev_b32 v5, 2, v1
    v_add_u32 v5, 147456, v5
    ds_write_b32 v5, v60
    v_lshlrev_b32 v5, 2, v3
    v_add_u32 v5, 161600, v5
    ds_write_b32 v5, v60
.L5:
    s_cmp_lg_u32 s78, 5
    s_cbranch_scc1 .L6
    v_lshlrev_b32 v5, 4, v1
    v_add_u32 v5, 158976, v5
    v_cmp_gt_u32 vcc, 41, v1
    s_and_saveexec_b64 s[8:9], vcc
    ds_write_b128 v5, v[60:63]
    s_mov_b64 exec, s[8:9]
.L6:
    s_waitcnt lgkmcnt(0)
.L4:
    s_barrier
    s_cmp_ge_u32 s78, 4
    s_cbranch_scc1 .Lsgrp7
    s_cmp_lg_u32 s78, 3
    s_cbranch_scc1 .L9
.L9:
    s_mov_b32 s72, s28
    s_and_b32 s73, s29, 0xffff
    s_mov_b32 s74, 8192
    s_mov_b32 s75, 0x20000
    v_lshlrev_b32 v4, 11, v2
    v_lshl_add_u32 v4, v3, 3, v4
    s_lshl_b32 s3, s77, 7
    v_add_u32 v4, s3, v4
    buffer_load_dwordx2 v[240:241], v4, s[72:75], 0 offen offset:0
    buffer_load_dwordx2 v[242:243], v4, s[72:75], 0 offen offset:512
    buffer_load_dwordx2 v[244:245], v4, s[72:75], 0 offen offset:1024
    buffer_load_dwordx2 v[246:247], v4, s[72:75], 0 offen offset:1536
    s_cmp_lg_u32 s78, 2
    s_cbranch_scc1 .L10
    s_lshr_b32 s3, s2, 3
    s_lshl_b32 s3, s3, 12
    s_lshl_b32 s4, s77, 7
    s_add_u32 s3, s3, s4
    v_lshrrev_b32 v4, 3, v1
    v_lshl_add_u32 v4, v4, 9, s3
    v_and_b32 v5, 7, v1
    v_lshl_add_u32 v4, v5, 4, v4
    s_mov_b32 s68, s24
    s_and_b32 s69, s25, 0xffff
    s_mov_b32 s70, 131072
    s_mov_b32 s71, 0x20000
    buffer_load_dwordx4 v[192:195], v4, s[68:71], 0 offen
    s_mov_b32 s68, s30
    s_and_b32 s69, s31, 0xffff
    s_mov_b32 s70, 131072
    s_mov_b32 s71, 0x20000
    buffer_load_dwordx4 v[192:195], v4, s[68:71], 0 offen
.L10:
    s_mov_b32 s64, s26
    s_and_b32 s65, s27, 0xffff
    s_mov_b32 s66, 131072
    s_mov_b32 s67, 0x20000
    s_mov_b32 s68, s32
    s_and_b32 s69, s33, 0xffff
    s_mov_b32 s70, 131072
    s_mov_b32 s71, 0x20000
    v_lshrrev_b32 v6, 4, v1
    v_and_b32 v6, 1, v6
    s_and_b32 s3, s79, 1
    s_lshl_b32 s3, s3, 1
    v_or_b32 v6, s3, v6
    v_bfe_u32 v7, v1, 1, 2
    v_xor_b32 v6, v6, v7
    v_lshlrev_b32 v6, 5, v6
    v_and_b32 v7, 1, v1
    v_lshl_add_u32 v6, v7, 4, v6
    v_lshrrev_b32 v7, 3, v1
    s_lshl_b32 s3, s79, 3
    v_add_u32 v7, s3, v7
    v_lshl_add_u32 v6, v7, 9, v6
    s_lshl_b32 s3, s77, 7
    v_add_u32 v6, s3, v6
    s_lshl_b32 s4, s79, 10
    s_add_u32 s4, s4, 81920
    s_mov_b32 s5, 0
    s_mov_b32 m0, s4
    s_add_u32 s4, s4, 4096
    buffer_load_dwordx4 v6, s[64:67], s5 offen lds
    s_add_u32 s5, s5, 16384
    s_mov_b32 m0, s4
    s_add_u32 s4, s4, 4096
    buffer_load_dwordx4 v6, s[64:67], s5 offen lds
    s_add_u32 s5, s5, 16384
    s_mov_b32 m0, s4
    s_add_u32 s4, s4, 4096
    buffer_load_dwordx4 v6, s[64:67], s5 offen lds
    s_add_u32 s5, s5, 16384
    s_mov_b32 m0, s4
    s_add_u32 s4, s4, 4096
    buffer_load_dwordx4 v6, s[64:67], s5 offen lds
    s_add_u32 s5, s5, 16384
    s_mov_b32 m0, s4
    s_add_u32 s4, s4, 4096
    buffer_load_dwordx4 v6, s[64:67], s5 offen lds
    s_add_u32 s5, s5, 16384
    s_mov_b32 m0, s4
    s_add_u32 s4, s4, 4096
    buffer_load_dwordx4 v6, s[64:67], s5 offen lds
    s_add_u32 s5, s5, 16384
    s_mov_b32 m0, s4
    s_add_u32 s4, s4, 4096
    buffer_load_dwordx4 v6, s[64:67], s5 offen lds
    s_add_u32 s5, s5, 16384
    s_mov_b32 m0, s4
    s_add_u32 s4, s4, 4096
    buffer_load_dwordx4 v6, s[64:67], s5 offen lds
    s_lshl_b32 s4, s79, 10
    s_add_u32 s4, s4, 114688
    s_mov_b32 s5, 0
    s_mov_b32 m0, s4
    s_add_u32 s4, s4, 4096
    buffer_load_dwordx4 v6, s[68:71], s5 offen lds
    s_add_u32 s5, s5, 16384
    s_mov_b32 m0, s4
    s_add_u32 s4, s4, 4096
    buffer_load_dwordx4 v6, s[68:71], s5 offen lds
    s_add_u32 s5, s5, 16384
    s_mov_b32 m0, s4
    s_add_u32 s4, s4, 4096
    buffer_load_dwordx4 v6, s[68:71], s5 offen lds
    s_add_u32 s5, s5, 16384
    s_mov_b32 m0, s4
    s_add_u32 s4, s4, 4096
    buffer_load_dwordx4 v6, s[68:71], s5 offen lds
    s_add_u32 s5, s5, 16384
    s_mov_b32 m0, s4
    s_add_u32 s4, s4, 4096
    buffer_load_dwordx4 v6, s[68:71], s5 offen lds
    s_add_u32 s5, s5, 16384
    s_mov_b32 m0, s4
    s_add_u32 s4, s4, 4096
    buffer_load_dwordx4 v6, s[68:71], s5 offen lds
    s_add_u32 s5, s5, 16384
    s_mov_b32 m0, s4
    s_add_u32 s4, s4, 4096
    buffer_load_dwordx4 v6, s[68:71], s5 offen lds
    s_add_u32 s5, s5, 16384
    s_mov_b32 m0, s4
    s_add_u32 s4, s4, 4096
    buffer_load_dwordx4 v6, s[68:71], s5 offen lds
    v_lshrrev_b32 v10, 5, v1
    v_and_b32 v11, 31, v1
    s_lshl_b32 s3, s78, 2
    s_add_u32 s3, s3, 0
    v_add_u32 v4, s3, v10
    v_xor_b32 v5, v11, v4
    v_lshlrev_b32 v5, 4, v5
    v_add_u32 v4, s99, v4
    v_lshl_add_u32 v8, v4, 9, v5
    s_lshl_b32 s3, s78, 2
    s_add_u32 s3, s3, 2
    v_add_u32 v4, s3, v10
    v_xor_b32 v5, v11, v4
    v_lshlrev_b32 v5, 4, v5
    v_add_u32 v4, s99, v4
    v_lshl_add_u32 v9, v4, 9, v5
    s_lshl_b32 s6, s78, 11
    s_add_u32 m0, s6, 0
    s_mov_b32 s5, 0
    buffer_load_dwordx4 v8, s[40:43], s5 offen lds
    s_add_u32 m0, s6, 1024
    s_mov_b32 s5, 0
    buffer_load_dwordx4 v9, s[40:43], s5 offen lds
    s_add_u32 m0, s6, 8192
    s_mov_b32 s5, 8192
    buffer_load_dwordx4 v8, s[40:43], s5 offen lds
    s_add_u32 m0, s6, 9216
    s_mov_b32 s5, 8192
    buffer_load_dwordx4 v9, s[40:43], s5 offen lds
    s_add_u32 m0, s6, 16384
    s_mov_b32 s5, 16384
    buffer_load_dwordx4 v8, s[40:43], s5 offen lds
    s_add_u32 m0, s6, 17408
    s_mov_b32 s5, 16384
    buffer_load_dwordx4 v9, s[40:43], s5 offen lds
    s_add_u32 m0, s6, 24576
    s_mov_b32 s5, 24576
    buffer_load_dwordx4 v8, s[40:43], s5 offen lds
    s_add_u32 m0, s6, 25600
    s_mov_b32 s5, 24576
    buffer_load_dwordx4 v9, s[40:43], s5 offen lds
    s_add_u32 m0, s6, 32768
    s_mov_b32 s5, 32768
    buffer_load_dwordx4 v8, s[40:43], s5 offen lds
    s_add_u32 m0, s6, 33792
    s_mov_b32 s5, 32768
    buffer_load_dwordx4 v9, s[40:43], s5 offen lds
    s_add_u32 m0, s6, 40960
    s_mov_b32 s5, 40960
    buffer_load_dwordx4 v8, s[40:43], s5 offen lds
    s_add_u32 m0, s6, 41984
    s_mov_b32 s5, 40960
    buffer_load_dwordx4 v9, s[40:43], s5 offen lds
    s_add_u32 m0, s6, 49152
    s_mov_b32 s5, 49152
    buffer_load_dwordx4 v8, s[40:43], s5 offen lds
    s_add_u32 m0, s6, 50176
    s_mov_b32 s5, 49152
    buffer_load_dwordx4 v9, s[40:43], s5 offen lds
    s_add_u32 m0, s6, 57344
    s_mov_b32 s5, 57344
    buffer_load_dwordx4 v8, s[40:43], s5 offen lds
    s_add_u32 m0, s6, 58368
    s_mov_b32 s5, 57344
    buffer_load_dwordx4 v9, s[40:43], s5 offen lds
    s_add_u32 m0, s6, 65536
    s_mov_b32 s5, 65536
    buffer_load_dwordx4 v8, s[40:43], s5 offen lds
    s_add_u32 m0, s6, 66560
    s_mov_b32 s5, 65536
    buffer_load_dwordx4 v9, s[40:43], s5 offen lds
    s_add_u32 m0, s6, 73728
    s_mov_b32 s5, 73728
    buffer_load_dwordx4 v8, s[40:43], s5 offen lds
    s_add_u32 m0, s6, 74752
    s_mov_b32 s5, 73728
    buffer_load_dwordx4 v9, s[40:43], s5 offen lds
    v_mov_b32 v47, 0
    global_load_dword v47, v47, s[36:37] sc1
    s_waitcnt vmcnt(37)
    s_mov_b32 s3, 3216550459
    v_lshlrev_b32 v208, 16, v240
    v_and_b32 v209, 0xffff0000, v240
    v_lshlrev_b32 v210, 16, v241
    v_and_b32 v211, 0xffff0000, v241
    v_lshlrev_b32 v212, 16, v242
    v_and_b32 v213, 0xffff0000, v242
    v_lshlrev_b32 v214, 16, v243
    v_and_b32 v215, 0xffff0000, v243
    v_lshlrev_b32 v216, 16, v244
    v_and_b32 v217, 0xffff0000, v244
    v_lshlrev_b32 v218, 16, v245
    v_and_b32 v219, 0xffff0000, v245
    v_lshlrev_b32 v220, 16, v246
    v_and_b32 v221, 0xffff0000, v246
    v_lshlrev_b32 v222, 16, v247
    v_and_b32 v223, 0xffff0000, v247
    v_mul_f32 v208, s3, v208
    v_mul_f32 v209, s3, v209
    v_mul_f32 v210, s3, v210
    v_mul_f32 v211, s3, v211
    v_mul_f32 v212, s3, v212
    v_mul_f32 v213, s3, v213
    v_mul_f32 v214, s3, v214
    v_mul_f32 v215, s3, v215
    v_mul_f32 v216, s3, v216
    v_mul_f32 v217, s3, v217
    v_mul_f32 v218, s3, v218
    v_mul_f32 v219, s3, v219
    v_mul_f32 v220, s3, v220
    v_mul_f32 v221, s3, v221
    v_mul_f32 v222, s3, v222
    v_mul_f32 v223, s3, v223
    v_cvt_pk_bf16_f32 v148, v208, v212
    v_cvt_pk_bf16_f32 v149, v216, v220
    v_cvt_pk_bf16_f32 v152, v209, v213
    v_cvt_pk_bf16_f32 v153, v217, v221
    v_cvt_pk_bf16_f32 v156, v210, v214
    v_cvt_pk_bf16_f32 v157, v218, v222
    v_cvt_pk_bf16_f32 v160, v211, v215
    v_cvt_pk_bf16_f32 v161, v219, v223
    v_xor_b32 v4, v2, v3
    v_and_b32 v4, 3, v4
    v_and_b32 v5, 12, v3
    v_xor_b32 v6, 0, v5
    v_add_u32 v6, v6, v4
    v_lshlrev_b32 v6, 4, v6
    v_lshl_add_u32 v168, v3, 9, v6
    v_add_u32 v140, 40960, v168
    v_xor_b32 v6, 4, v5
    v_add_u32 v6, v6, v4
    v_lshlrev_b32 v6, 4, v6
    v_lshl_add_u32 v169, v3, 9, v6
    v_add_u32 v141, 40960, v169
    v_xor_b32 v6, 8, v5
    v_add_u32 v6, v6, v4
    v_lshlrev_b32 v6, 4, v6
    v_lshl_add_u32 v170, v3, 9, v6
    v_add_u32 v142, 40960, v170
    v_xor_b32 v6, 12, v5
    v_add_u32 v6, v6, v4
    v_lshlrev_b32 v6, 4, v6
    v_lshl_add_u32 v171, v3, 9, v6
    v_add_u32 v143, 40960, v171
    s_lshl_b32 s6, s79, 6
    v_lshl_add_u32 v46, v14, 4, s6
    v_lshrrev_b32 v147, 2, v1
    v_lshl_add_u32 v146, v14, 4, v147
    v_lshlrev_b32 v146, 2, v146
    s_waitcnt vmcnt(13)
    s_waitcnt lgkmcnt(0)
    v_mov_b32 v10, 161608
    v_mov_b32 v11, 1
    s_mov_b64 s[8:9], exec
    s_mov_b64 exec, 1
    ds_add_u32 v10, v11
    s_mov_b64 exec, s[8:9]
    v_mov_b32 v10, 161608
    s_mov_b32 s3, 0x200000
.L11:
    ds_read_b32 v11, v10
    s_waitcnt lgkmcnt(0)
    v_readfirstlane_b32 s4, v11
    s_nop 3
    s_cmp_ge_u32 s4, 4
    s_cbranch_scc1 .L12
    s_sub_u32 s3, s3, 1
    s_cmp_lg_u32 s3, 0
    s_cbranch_scc1 .L11
.L12:
    v_bfe_u32 v4, v1, 3, 1
    v_and_b32 v5, 1, v2
    v_lshl_or_b32 v4, v5, 1, v4
    v_xor_b32 v4, s79, v4
    v_lshlrev_b32 v4, 5, v4
    v_lshl_add_u32 v4, v14, 3, v4
    v_bfe_u32 v5, v1, 2, 2
    v_lshl_add_u32 v5, v2, 3, v5
    v_lshl_add_u32 v4, v5, 7, v4
    v_add_u32 v136, 81920, v4
    v_add_u32 v137, 114688, v4
    ds_read_b64_tr_b16 v[48:49], v136 offset:0
    ds_read_b64_tr_b16 v[50:51], v136 offset:512
    ds_read_b64_tr_b16 v[52:53], v136 offset:4096
    ds_read_b64_tr_b16 v[54:55], v136 offset:4608
    ds_read_b64_tr_b16 v[56:57], v136 offset:8192
    ds_read_b64_tr_b16 v[58:59], v136 offset:8704
    ds_read_b64_tr_b16 v[60:61], v136 offset:12288
    ds_read_b64_tr_b16 v[62:63], v136 offset:12800
    ds_read_b64_tr_b16 v[64:65], v136 offset:16384
    ds_read_b64_tr_b16 v[66:67], v136 offset:16896
    ds_read_b64_tr_b16 v[68:69], v136 offset:20480
    ds_read_b64_tr_b16 v[70:71], v136 offset:20992
    s_waitcnt lgkmcnt(4)
    ds_read_b64_tr_b16 v[72:73], v136 offset:24576
    ds_read_b64_tr_b16 v[74:75], v136 offset:25088
    ds_read_b64_tr_b16 v[76:77], v136 offset:28672
    ds_read_b64_tr_b16 v[78:79], v136 offset:29184
    ds_read_b64_tr_b16 v[80:81], v137 offset:0
    ds_read_b64_tr_b16 v[82:83], v137 offset:512
    ds_read_b64_tr_b16 v[84:85], v137 offset:4096
    ds_read_b64_tr_b16 v[86:87], v137 offset:4608
    ds_read_b64_tr_b16 v[88:89], v137 offset:8192
    ds_read_b64_tr_b16 v[90:91], v137 offset:8704
    ds_read_b64_tr_b16 v[92:93], v137 offset:12288
    ds_read_b64_tr_b16 v[94:95], v137 offset:12800
    s_waitcnt lgkmcnt(4)
    ds_read_b64_tr_b16 v[96:97], v137 offset:16384
    ds_read_b64_tr_b16 v[98:99], v137 offset:16896
    ds_read_b64_tr_b16 v[100:101], v137 offset:20480
    ds_read_b64_tr_b16 v[102:103], v137 offset:20992
    ds_read_b64_tr_b16 v[104:105], v137 offset:24576
    ds_read_b64_tr_b16 v[106:107], v137 offset:25088
    ds_read_b64_tr_b16 v[108:109], v137 offset:28672
    ds_read_b64_tr_b16 v[110:111], v137 offset:29184
    s_waitcnt lgkmcnt(0)
    ds_read_b128 v[176:179], v168 offset:0
    ds_read_b128 v[180:183], v169 offset:0
    ds_read_b128 v[184:187], v170 offset:0
    ds_read_b128 v[188:191], v171 offset:0
    ds_read_b128 v[192:195], v168 offset:256
    ds_read_b128 v[196:199], v169 offset:256
    ds_read_b128 v[200:203], v170 offset:256
    s_waitcnt lgkmcnt(6)
    v_mfma_f32_16x16x32_bf16 v[112:115], v[48:51], v[176:179], 0
    v_mfma_f32_16x16x32_bf16 v[124:127], v[80:83], v[176:179], 0
    ds_read_b128 v[204:207], v171 offset:256
    s_waitcnt lgkmcnt(6)
    v_mfma_f32_16x16x32_bf16 v[112:115], v[52:55], v[180:183], v[112:115]
    v_mfma_f32_16x16x32_bf16 v[124:127], v[84:87], v[180:183], v[124:127]
    ds_read_b128 v[176:179], v168 offset:8192
    s_waitcnt lgkmcnt(6)
    v_mfma_f32_16x16x32_bf16 v[112:115], v[56:59], v[184:187], v[112:115]
    v_mfma_f32_16x16x32_bf16 v[124:127], v[88:91], v[184:187], v[124:127]
    ds_read_b128 v[180:183], v169 offset:8192
    s_waitcnt lgkmcnt(6)
    v_mfma_f32_16x16x32_bf16 v[112:115], v[60:63], v[188:191], v[112:115]
    v_mfma_f32_16x16x32_bf16 v[124:127], v[92:95], v[188:191], v[124:127]
    ds_read_b128 v[184:187], v170 offset:8192
    s_waitcnt lgkmcnt(6)
    v_mfma_f32_16x16x32_bf16 v[112:115], v[64:67], v[192:195], v[112:115]
    v_mfma_f32_16x16x32_bf16 v[124:127], v[96:99], v[192:195], v[124:127]
    ds_read_b128 v[188:191], v171 offset:8192
    s_waitcnt lgkmcnt(6)
    v_mfma_f32_16x16x32_bf16 v[112:115], v[68:71], v[196:199], v[112:115]
    v_mfma_f32_16x16x32_bf16 v[124:127], v[100:103], v[196:199], v[124:127]
    ds_read_b128 v[192:195], v168 offset:8448
    s_waitcnt lgkmcnt(6)
    v_mfma_f32_16x16x32_bf16 v[112:115], v[72:75], v[200:203], v[112:115]
    v_mfma_f32_16x16x32_bf16 v[124:127], v[104:107], v[200:203], v[124:127]
    ds_read_b128 v[196:199], v169 offset:8448
    s_waitcnt lgkmcnt(6)
    v_mfma_f32_16x16x32_bf16 v[112:115], v[76:79], v[204:207], v[112:115]
    v_mfma_f32_16x16x32_bf16 v[124:127], v[108:111], v[204:207], v[124:127]
    ds_read_b128 v[200:203], v170 offset:8448
    s_waitcnt lgkmcnt(6)
    v_mfma_f32_16x16x32_bf16 v[116:119], v[48:51], v[176:179], 0
    v_mfma_f32_16x16x32_bf16 v[128:131], v[80:83], v[176:179], 0
    ds_read_b128 v[204:207], v171 offset:8448
    s_waitcnt lgkmcnt(6)
    v_mfma_f32_16x16x32_bf16 v[116:119], v[52:55], v[180:183], v[116:119]
    s_mov_b32 s3, 3216550459
    s_brev_b32 s8, 1
    s_mov_b32 s9, 0xffff0000
    v_cvt_pk_bf16_f32 v210, v124, v125
    v_mfma_f32_16x16x32_bf16 v[128:131], v[84:87], v[180:183], v[128:131]
    ds_read_b128 v[176:179], v168 offset:16384
    v_cvt_pk_bf16_f32 v211, v126, v127
    v_and_b32 v172, 0x7fffffff, v125
    v_and_b32 v173, 0x7fffffff, v127
    v_mul_f32 v112, s3, v112
    s_waitcnt lgkmcnt(6)
    v_mfma_f32_16x16x32_bf16 v[116:119], v[56:59], v[184:187], v[116:119]
    v_mul_f32 v113, s3, v113
    v_mul_f32 v114, s3, v114
    v_mul_f32 v115, s3, v115
    v_add_u32 v172, 0x8000, v172
    v_mfma_f32_16x16x32_bf16 v[128:131], v[88:91], v[184:187], v[128:131]
    ds_read_b128 v[180:183], v169 offset:16384
    v_add_u32 v173, 0x8000, v173
    v_cvt_pk_bf16_f32 v208, v112, v113
    v_cvt_pk_bf16_f32 v209, v114, v115
    v_sub_u32_sdwa v172, v172, v210 clamp dst_sel:DWORD dst_unused:UNUSED_PAD src0_sel:DWORD src1_sel:WORD_0
    s_waitcnt lgkmcnt(6)
    v_mfma_f32_16x16x32_bf16 v[116:119], v[60:63], v[188:191], v[116:119]
    v_sub_u32_sdwa v173, v173, v211 clamp dst_sel:DWORD dst_unused:UNUSED_PAD src0_sel:DWORD src1_sel:WORD_0
    v_and_or_b32 v172, v125, s8, v172
    v_and_or_b32 v173, v127, s8, v173
    v_bfi_b32 v210, s9, v172, v210
    v_mfma_f32_16x16x32_bf16 v[128:131], v[92:95], v[188:191], v[128:131]
    ds_read_b128 v[184:187], v170 offset:16384
    v_bfi_b32 v211, s9, v173, v211
    ds_bpermute_b32 v208, v146, v208
    ds_bpermute_b32 v209, v146, v209
    ds_bpermute_b32 v210, v146, v210
    s_waitcnt lgkmcnt(9)
    v_mfma_f32_16x16x32_bf16 v[116:119], v[64:67], v[192:195], v[116:119]
    ds_bpermute_b32 v211, v146, v211
    v_mfma_f32_16x16x32_bf16 v[128:131], v[96:99], v[192:195], v[128:131]
    ds_read_b128 v[188:191], v171 offset:16384
    s_waitcnt lgkmcnt(10)
    v_mfma_f32_16x16x32_bf16 v[116:119], v[68:71], v[196:199], v[116:119]
    v_mfma_f32_16x16x32_bf16 v[128:131], v[100:103], v[196:199], v[128:131]
    ds_read_b128 v[192:195], v168 offset:16640
    s_waitcnt lgkmcnt(10)
    v_mfma_f32_16x16x32_bf16 v[116:119], v[72:75], v[200:203], v[116:119]
    v_mfma_f32_16x16x32_bf16 v[128:131], v[104:107], v[200:203], v[128:131]
    ds_read_b128 v[196:199], v169 offset:16640
    s_waitcnt lgkmcnt(10)
    v_mfma_f32_16x16x32_bf16 v[116:119], v[76:79], v[204:207], v[116:119]
    v_mfma_f32_16x16x32_bf16 v[128:131], v[108:111], v[204:207], v[128:131]
    ds_read_b128 v[200:203], v170 offset:16640
    s_waitcnt lgkmcnt(10)
    v_mfma_f32_16x16x32_bf16 v[120:123], v[48:51], v[176:179], 0
    v_mfma_f32_16x16x32_bf16 v[132:135], v[80:83], v[176:179], 0
    ds_read_b128 v[204:207], v171 offset:16640
    s_waitcnt lgkmcnt(10)
    v_mfma_f32_16x16x32_bf16 v[120:123], v[52:55], v[180:183], v[120:123]
    s_waitcnt lgkmcnt(5)
    v_add_u32 v8, 0, v147
    v_add_u32 v9, s99, v8
    v_cmp_gt_u32 vcc, s81, v8
    v_mfma_f32_16x16x32_bf16 v[132:135], v[84:87], v[180:183], v[132:135]
    ds_read_b128 v[176:179], v168 offset:24576
    v_lshl_add_u32 v9, v9, 8, v46
    v_mov_b32 v8, 0x80000000
    v_cndmask_b32 v9, v8, v9, vcc
    buffer_store_dwordx4 v[208:211], v9, s[48:51], 0 offen sc1
    s_waitcnt lgkmcnt(10)
    v_mfma_f32_16x16x32_bf16 v[120:123], v[56:59], v[184:187], v[120:123]
    s_mov_b32 s3, 3216550459
    s_brev_b32 s8, 1
    s_mov_b32 s9, 0xffff0000
    v_cvt_pk_bf16_f32 v214, v128, v129
    v_mfma_f32_16x16x32_bf16 v[132:135], v[88:91], v[184:187], v[132:135]
    ds_read_b128 v[180:183], v169 offset:24576
    v_cvt_pk_bf16_f32 v215, v130, v131
    v_and_b32 v172, 0x7fffffff, v129
    v_and_b32 v173, 0x7fffffff, v131
    v_mul_f32 v116, s3, v116
    s_waitcnt lgkmcnt(6)
    v_mfma_f32_16x16x32_bf16 v[120:123], v[60:63], v[188:191], v[120:123]
    v_mul_f32 v117, s3, v117
    v_mul_f32 v118, s3, v118
    v_mul_f32 v119, s3, v119
    v_add_u32 v172, 0x8000, v172
    v_mfma_f32_16x16x32_bf16 v[132:135], v[92:95], v[188:191], v[132:135]
    ds_read_b128 v[184:187], v170 offset:24576
    v_add_u32 v173, 0x8000, v173
    v_cvt_pk_bf16_f32 v212, v116, v117
    v_cvt_pk_bf16_f32 v213, v118, v119
    v_sub_u32_sdwa v172, v172, v214 clamp dst_sel:DWORD dst_unused:UNUSED_PAD src0_sel:DWORD src1_sel:WORD_0
    s_waitcnt lgkmcnt(6)
    v_mfma_f32_16x16x32_bf16 v[120:123], v[64:67], v[192:195], v[120:123]
    v_sub_u32_sdwa v173, v173, v215 clamp dst_sel:DWORD dst_unused:UNUSED_PAD src0_sel:DWORD src1_sel:WORD_0
    v_and_or_b32 v172, v129, s8, v172
    v_and_or_b32 v173, v131, s8, v173
    v_bfi_b32 v214, s9, v172, v214
    v_mfma_f32_16x16x32_bf16 v[132:135], v[96:99], v[192:195], v[132:135]
    ds_read_b128 v[188:191], v171 offset:24576
    v_bfi_b32 v215, s9, v173, v215
    ds_bpermute_b32 v212, v146, v212
    ds_bpermute_b32 v213, v146, v213
    ds_bpermute_b32 v214, v146, v214
    s_waitcnt lgkmcnt(9)
    v_mfma_f32_16x16x32_bf16 v[120:123], v[68:71], v[196:199], v[120:123]
    ds_bpermute_b32 v215, v146, v215
    v_mfma_f32_16x16x32_bf16 v[132:135], v[100:103], v[196:199], v[132:135]
    ds_read_b128 v[192:195], v168 offset:24832
    s_waitcnt lgkmcnt(10)
    v_mfma_f32_16x16x32_bf16 v[120:123], v[72:75], v[200:203], v[120:123]
    v_mfma_f32_16x16x32_bf16 v[132:135], v[104:107], v[200:203], v[132:135]
    ds_read_b128 v[196:199], v169 offset:24832
    s_waitcnt lgkmcnt(10)
    v_mfma_f32_16x16x32_bf16 v[120:123], v[76:79], v[204:207], v[120:123]
    v_mfma_f32_16x16x32_bf16 v[132:135], v[108:111], v[204:207], v[132:135]
    ds_read_b128 v[200:203], v170 offset:24832
    s_waitcnt lgkmcnt(10)
    v_mfma_f32_16x16x32_bf16 v[112:115], v[48:51], v[176:179], 0
    v_mfma_f32_16x16x32_bf16 v[124:127], v[80:83], v[176:179], 0
    ds_read_b128 v[204:207], v171 offset:24832
    s_waitcnt lgkmcnt(10)
    v_mfma_f32_16x16x32_bf16 v[112:115], v[52:55], v[180:183], v[112:115]
    s_waitcnt lgkmcnt(4)
    v_add_u32 v8, 16, v147
    v_add_u32 v9, s99, v8
    v_cmp_gt_u32 vcc, s81, v8
    v_mfma_f32_16x16x32_bf16 v[124:127], v[84:87], v[180:183], v[124:127]
    v_lshl_add_u32 v9, v9, 8, v46
    v_mov_b32 v8, 0x80000000
    v_cndmask_b32 v9, v8, v9, vcc
    buffer_store_dwordx4 v[212:215], v9, s[48:51], 0 offen sc1
    s_waitcnt lgkmcnt(9)
    v_mfma_f32_16x16x32_bf16 v[112:115], v[56:59], v[184:187], v[112:115]
    s_mov_b32 s3, 3216550459
    s_brev_b32 s8, 1
    s_mov_b32 s9, 0xffff0000
    v_cvt_pk_bf16_f32 v218, v132, v133
    v_mfma_f32_16x16x32_bf16 v[124:127], v[88:91], v[184:187], v[124:127]
    v_cvt_pk_bf16_f32 v219, v134, v135
    v_and_b32 v172, 0x7fffffff, v133
    v_and_b32 v173, 0x7fffffff, v135
    v_mul_f32 v120, s3, v120
    s_waitcnt lgkmcnt(8)
    v_mfma_f32_16x16x32_bf16 v[112:115], v[60:63], v[188:191], v[112:115]
    v_mul_f32 v121, s3, v121
    v_mul_f32 v122, s3, v122
    v_mul_f32 v123, s3, v123
    v_add_u32 v172, 0x8000, v172
    v_mfma_f32_16x16x32_bf16 v[124:127], v[92:95], v[188:191], v[124:127]
    v_add_u32 v173, 0x8000, v173
    v_cvt_pk_bf16_f32 v216, v120, v121
    v_cvt_pk_bf16_f32 v217, v122, v123
    v_sub_u32_sdwa v172, v172, v218 clamp dst_sel:DWORD dst_unused:UNUSED_PAD src0_sel:DWORD src1_sel:WORD_0
    s_waitcnt lgkmcnt(3)
    v_mfma_f32_16x16x32_bf16 v[112:115], v[64:67], v[192:195], v[112:115]
    v_sub_u32_sdwa v173, v173, v219 clamp dst_sel:DWORD dst_unused:UNUSED_PAD src0_sel:DWORD src1_sel:WORD_0
    v_and_or_b32 v172, v133, s8, v172
    v_and_or_b32 v173, v135, s8, v173
    v_bfi_b32 v218, s9, v172, v218
    v_mfma_f32_16x16x32_bf16 v[124:127], v[96:99], v[192:195], v[124:127]
    v_bfi_b32 v219, s9, v173, v219
    ds_bpermute_b32 v216, v146, v216
    ds_bpermute_b32 v217, v146, v217
    ds_bpermute_b32 v218, v146, v218
    s_waitcnt lgkmcnt(5)
    v_mfma_f32_16x16x32_bf16 v[112:115], v[68:71], v[196:199], v[112:115]
    ds_bpermute_b32 v219, v146, v219
    v_mfma_f32_16x16x32_bf16 v[124:127], v[100:103], v[196:199], v[124:127]
    s_waitcnt lgkmcnt(5)
    v_mfma_f32_16x16x32_bf16 v[112:115], v[72:75], v[200:203], v[112:115]
    v_mfma_f32_16x16x32_bf16 v[124:127], v[104:107], v[200:203], v[124:127]
    s_waitcnt lgkmcnt(4)
    v_mfma_f32_16x16x32_bf16 v[112:115], v[76:79], v[204:207], v[112:115]
    v_mfma_f32_16x16x32_bf16 v[124:127], v[108:111], v[204:207], v[124:127]
    s_waitcnt lgkmcnt(0)
    v_add_u32 v8, 32, v147
    v_add_u32 v9, s99, v8
    v_cmp_gt_u32 vcc, s81, v8
    v_lshl_add_u32 v9, v9, 8, v46
    v_mov_b32 v8, 0x80000000
    v_cndmask_b32 v9, v8, v9, vcc
    buffer_store_dwordx4 v[216:219], v9, s[48:51], 0 offen sc1
    s_waitcnt vmcnt(4)
    s_waitcnt lgkmcnt(0)
    v_mov_b32 v10, 161612
    v_mov_b32 v11, 1
    s_mov_b64 s[8:9], exec
    s_mov_b64 exec, 1
    ds_add_u32 v10, v11
    s_mov_b64 exec, s[8:9]
    v_mov_b32 v10, 161612
    s_mov_b32 s3, 0x200000
.L13:
    ds_read_b32 v11, v10
    s_waitcnt lgkmcnt(0)
    v_readfirstlane_b32 s4, v11
    s_nop 3
    s_cmp_ge_u32 s4, 4
    s_cbranch_scc1 .L14
    s_sub_u32 s3, s3, 1
    s_cmp_lg_u32 s3, 0
    s_cbranch_scc1 .L13
.L14:
    ds_read_b128 v[176:179], v168 offset:32768
    ds_read_b128 v[180:183], v169 offset:32768
    ds_read_b128 v[184:187], v170 offset:32768
    ds_read_b128 v[188:191], v171 offset:32768
    ds_read_b128 v[192:195], v168 offset:33024
    ds_read_b128 v[196:199], v169 offset:33024
    ds_read_b128 v[200:203], v170 offset:33024
    s_waitcnt lgkmcnt(6)
    v_mfma_f32_16x16x32_bf16 v[116:119], v[48:51], v[176:179], 0
    v_mfma_f32_16x16x32_bf16 v[128:131], v[80:83], v[176:179], 0
    ds_read_b128 v[204:207], v171 offset:33024
    s_waitcnt lgkmcnt(6)
    v_mfma_f32_16x16x32_bf16 v[116:119], v[52:55], v[180:183], v[116:119]
    s_mov_b32 s3, 3216550459
    s_brev_b32 s8, 1
    s_mov_b32 s9, 0xffff0000
    v_cvt_pk_bf16_f32 v222, v124, v125
    v_mfma_f32_16x16x32_bf16 v[128:131], v[84:87], v[180:183], v[128:131]
    ds_read_b128 v[176:179], v140 offset:0
    v_cvt_pk_bf16_f32 v223, v126, v127
    v_and_b32 v172, 0x7fffffff, v125
    v_and_b32 v173, 0x7fffffff, v127
    v_mul_f32 v112, s3, v112
    s_waitcnt lgkmcnt(6)
    v_mfma_f32_16x16x32_bf16 v[116:119], v[56:59], v[184:187], v[116:119]
    v_mul_f32 v113, s3, v113
    v_mul_f32 v114, s3, v114
    v_mul_f32 v115, s3, v115
    v_add_u32 v172, 0x8000, v172
    v_mfma_f32_16x16x32_bf16 v[128:131], v[88:91], v[184:187], v[128:131]
    ds_read_b128 v[180:183], v141 offset:0
    v_add_u32 v173, 0x8000, v173
    v_cvt_pk_bf16_f32 v220, v112, v113
    v_cvt_pk_bf16_f32 v221, v114, v115
    v_sub_u32_sdwa v172, v172, v222 clamp dst_sel:DWORD dst_unused:UNUSED_PAD src0_sel:DWORD src1_sel:WORD_0
    s_waitcnt lgkmcnt(6)
    v_mfma_f32_16x16x32_bf16 v[116:119], v[60:63], v[188:191], v[116:119]
    v_sub_u32_sdwa v173, v173, v223 clamp dst_sel:DWORD dst_unused:UNUSED_PAD src0_sel:DWORD src1_sel:WORD_0
    v_and_or_b32 v172, v125, s8, v172
    v_and_or_b32 v173, v127, s8, v173
    v_bfi_b32 v222, s9, v172, v222
    v_mfma_f32_16x16x32_bf16 v[128:131], v[92:95], v[188:191], v[128:131]
    ds_read_b128 v[184:187], v142 offset:0
    v_bfi_b32 v223, s9, v173, v223
    ds_bpermute_b32 v220, v146, v220
    ds_bpermute_b32 v221, v146, v221
    ds_bpermute_b32 v222, v146, v222
    s_waitcnt lgkmcnt(9)
    v_mfma_f32_16x16x32_bf16 v[116:119], v[64:67], v[192:195], v[116:119]
    ds_bpermute_b32 v223, v146, v223
    v_mfma_f32_16x16x32_bf16 v[128:131], v[96:99], v[192:195], v[128:131]
    ds_read_b128 v[188:191], v143 offset:0
    s_waitcnt lgkmcnt(10)
    v_mfma_f32_16x16x32_bf16 v[116:119], v[68:71], v[196:199], v[116:119]
    v_mfma_f32_16x16x32_bf16 v[128:131], v[100:103], v[196:199], v[128:131]
    ds_read_b128 v[192:195], v140 offset:256
    s_waitcnt lgkmcnt(10)
    v_mfma_f32_16x16x32_bf16 v[116:119], v[72:75], v[200:203], v[116:119]
    v_mfma_f32_16x16x32_bf16 v[128:131], v[104:107], v[200:203], v[128:131]
    ds_read_b128 v[196:199], v141 offset:256
    s_waitcnt lgkmcnt(10)
    v_mfma_f32_16x16x32_bf16 v[116:119], v[76:79], v[204:207], v[116:119]
    v_mfma_f32_16x16x32_bf16 v[128:131], v[108:111], v[204:207], v[128:131]
    ds_read_b128 v[200:203], v142 offset:256
    s_waitcnt lgkmcnt(10)
    v_mfma_f32_16x16x32_bf16 v[120:123], v[48:51], v[176:179], 0
    v_mfma_f32_16x16x32_bf16 v[132:135], v[80:83], v[176:179], 0
    ds_read_b128 v[204:207], v143 offset:256
    s_waitcnt lgkmcnt(10)
    v_mfma_f32_16x16x32_bf16 v[120:123], v[52:55], v[180:183], v[120:123]
    s_mov_b32 s3, 3216550459
    s_brev_b32 s8, 1
    s_mov_b32 s9, 0xffff0000
    v_cvt_pk_bf16_f32 v226, v128, v129
    v_mfma_f32_16x16x32_bf16 v[132:135], v[84:87], v[180:183], v[132:135]
    ds_read_b128 v[176:179], v140 offset:8192
    v_cvt_pk_bf16_f32 v227, v130, v131
    v_and_b32 v172, 0x7fffffff, v129
    v_and_b32 v173, 0x7fffffff, v131
    v_mul_f32 v116, s3, v116
    s_waitcnt lgkmcnt(10)
    v_mfma_f32_16x16x32_bf16 v[120:123], v[56:59], v[184:187], v[120:123]
    v_mul_f32 v117, s3, v117
    v_mul_f32 v118, s3, v118
    v_mul_f32 v119, s3, v119
    v_add_u32 v172, 0x8000, v172
    v_mfma_f32_16x16x32_bf16 v[132:135], v[88:91], v[184:187], v[132:135]
    ds_read_b128 v[180:183], v141 offset:8192
    v_add_u32 v173, 0x8000, v173
    v_cvt_pk_bf16_f32 v224, v116, v117
    v_cvt_pk_bf16_f32 v225, v118, v119
    v_sub_u32_sdwa v172, v172, v226 clamp dst_sel:DWORD dst_unused:UNUSED_PAD src0_sel:DWORD src1_sel:WORD_0
    s_waitcnt lgkmcnt(6)
    v_mfma_f32_16x16x32_bf16 v[120:123], v[60:63], v[188:191], v[120:123]
    v_sub_u32_sdwa v173, v173, v227 clamp dst_sel:DWORD dst_unused:UNUSED_PAD src0_sel:DWORD src1_sel:WORD_0
    v_and_or_b32 v172, v129, s8, v172
    v_and_or_b32 v173, v131, s8, v173
    v_bfi_b32 v226, s9, v172, v226
    v_mfma_f32_16x16x32_bf16 v[132:135], v[92:95], v[188:191], v[132:135]
    ds_read_b128 v[184:187], v142 offset:8192
    v_bfi_b32 v227, s9, v173, v227
    ds_bpermute_b32 v224, v146, v224
    ds_bpermute_b32 v225, v146, v225
    ds_bpermute_b32 v226, v146, v226
    s_waitcnt lgkmcnt(9)
    v_mfma_f32_16x16x32_bf16 v[120:123], v[64:67], v[192:195], v[120:123]
    ds_bpermute_b32 v227, v146, v227
    v_mfma_f32_16x16x32_bf16 v[132:135], v[96:99], v[192:195], v[132:135]
    ds_read_b128 v[188:191], v143 offset:8192
    s_waitcnt lgkmcnt(10)
    v_mfma_f32_16x16x32_bf16 v[120:123], v[68:71], v[196:199], v[120:123]
    v_mfma_f32_16x16x32_bf16 v[132:135], v[100:103], v[196:199], v[132:135]
    ds_read_b128 v[192:195], v140 offset:8448
    s_waitcnt lgkmcnt(10)
    v_mfma_f32_16x16x32_bf16 v[120:123], v[72:75], v[200:203], v[120:123]
    v_mfma_f32_16x16x32_bf16 v[132:135], v[104:107], v[200:203], v[132:135]
    ds_read_b128 v[196:199], v141 offset:8448
    s_waitcnt lgkmcnt(10)
    v_mfma_f32_16x16x32_bf16 v[120:123], v[76:79], v[204:207], v[120:123]
    v_mfma_f32_16x16x32_bf16 v[132:135], v[108:111], v[204:207], v[132:135]
    ds_read_b128 v[200:203], v142 offset:8448
    s_waitcnt lgkmcnt(10)
    v_mfma_f32_16x16x32_bf16 v[112:115], v[48:51], v[176:179], 0
    v_mfma_f32_16x16x32_bf16 v[124:127], v[80:83], v[176:179], 0
    ds_read_b128 v[204:207], v143 offset:8448
    s_waitcnt lgkmcnt(10)
    v_mfma_f32_16x16x32_bf16 v[112:115], v[52:55], v[180:183], v[112:115]
    s_mov_b32 s3, 3216550459
    s_brev_b32 s8, 1
    s_mov_b32 s9, 0xffff0000
    v_cvt_pk_bf16_f32 v230, v132, v133
    v_mfma_f32_16x16x32_bf16 v[124:127], v[84:87], v[180:183], v[124:127]
    ds_read_b128 v[176:179], v140 offset:16384
    v_cvt_pk_bf16_f32 v231, v134, v135
    v_and_b32 v172, 0x7fffffff, v133
    v_and_b32 v173, 0x7fffffff, v135
    v_mul_f32 v120, s3, v120
    s_waitcnt lgkmcnt(10)
    v_mfma_f32_16x16x32_bf16 v[112:115], v[56:59], v[184:187], v[112:115]
    v_mul_f32 v121, s3, v121
    v_mul_f32 v122, s3, v122
    v_mul_f32 v123, s3, v123
    v_add_u32 v172, 0x8000, v172
    v_mfma_f32_16x16x32_bf16 v[124:127], v[88:91], v[184:187], v[124:127]
    ds_read_b128 v[180:183], v141 offset:16384
    v_add_u32 v173, 0x8000, v173
    v_cvt_pk_bf16_f32 v228, v120, v121
    v_cvt_pk_bf16_f32 v229, v122, v123
    v_sub_u32_sdwa v172, v172, v230 clamp dst_sel:DWORD dst_unused:UNUSED_PAD src0_sel:DWORD src1_sel:WORD_0
    s_waitcnt lgkmcnt(6)
    v_mfma_f32_16x16x32_bf16 v[112:115], v[60:63], v[188:191], v[112:115]
    v_sub_u32_sdwa v173, v173, v231 clamp dst_sel:DWORD dst_unused:UNUSED_PAD src0_sel:DWORD src1_sel:WORD_0
    v_and_or_b32 v172, v133, s8, v172
    v_and_or_b32 v173, v135, s8, v173
    v_bfi_b32 v230, s9, v172, v230
    v_mfma_f32_16x16x32_bf16 v[124:127], v[92:95], v[188:191], v[124:127]
    ds_read_b128 v[184:187], v142 offset:16384
    v_bfi_b32 v231, s9, v173, v231
    ds_bpermute_b32 v228, v146, v228
    ds_bpermute_b32 v229, v146, v229
    ds_bpermute_b32 v230, v146, v230
    s_waitcnt lgkmcnt(9)
    v_mfma_f32_16x16x32_bf16 v[112:115], v[64:67], v[192:195], v[112:115]
    ds_bpermute_b32 v231, v146, v231
    v_mfma_f32_16x16x32_bf16 v[124:127], v[96:99], v[192:195], v[124:127]
    ds_read_b128 v[188:191], v143 offset:16384
    s_waitcnt lgkmcnt(10)
    v_mfma_f32_16x16x32_bf16 v[112:115], v[68:71], v[196:199], v[112:115]
    v_mfma_f32_16x16x32_bf16 v[124:127], v[100:103], v[196:199], v[124:127]
    ds_read_b128 v[192:195], v140 offset:16640
    s_waitcnt lgkmcnt(10)
    v_mfma_f32_16x16x32_bf16 v[112:115], v[72:75], v[200:203], v[112:115]
    v_mfma_f32_16x16x32_bf16 v[124:127], v[104:107], v[200:203], v[124:127]
    ds_read_b128 v[196:199], v141 offset:16640
    s_waitcnt lgkmcnt(10)
    v_mfma_f32_16x16x32_bf16 v[112:115], v[76:79], v[204:207], v[112:115]
    v_mfma_f32_16x16x32_bf16 v[124:127], v[108:111], v[204:207], v[124:127]
    ds_read_b128 v[200:203], v142 offset:16640
    s_waitcnt lgkmcnt(10)
    v_mfma_f32_16x16x32_bf16 v[116:119], v[48:51], v[176:179], 0
    v_mfma_f32_16x16x32_bf16 v[128:131], v[80:83], v[176:179], 0
    ds_read_b128 v[204:207], v143 offset:16640
    s_waitcnt lgkmcnt(10)
    v_mfma_f32_16x16x32_bf16 v[116:119], v[52:55], v[180:183], v[116:119]
    s_mov_b32 s3, 3216550459
    s_brev_b32 s8, 1
    s_mov_b32 s9, 0xffff0000
    v_cvt_pk_bf16_f32 v234, v124, v125
    v_mfma_f32_16x16x32_bf16 v[128:131], v[84:87], v[180:183], v[128:131]
    ds_read_b128 v[176:179], v140 offset:24576
    v_cvt_pk_bf16_f32 v235, v126, v127
    v_and_b32 v172, 0x7fffffff, v125
    v_and_b32 v173, 0x7fffffff, v127
    v_mul_f32 v112, s3, v112
    s_waitcnt lgkmcnt(10)
    v_mfma_f32_16x16x32_bf16 v[116:119], v[56:59], v[184:187], v[116:119]
    v_mul_f32 v113, s3, v113
    v_mul_f32 v114, s3, v114
    v_mul_f32 v115, s3, v115
    v_add_u32 v172, 0x8000, v172
    v_mfma_f32_16x16x32_bf16 v[128:131], v[88:91], v[184:187], v[128:131]
    ds_read_b128 v[180:183], v141 offset:24576
    v_add_u32 v173, 0x8000, v173
    v_cvt_pk_bf16_f32 v232, v112, v113
    v_cvt_pk_bf16_f32 v233, v114, v115
    v_sub_u32_sdwa v172, v172, v234 clamp dst_sel:DWORD dst_unused:UNUSED_PAD src0_sel:DWORD src1_sel:WORD_0
    s_waitcnt lgkmcnt(6)
    v_mfma_f32_16x16x32_bf16 v[116:119], v[60:63], v[188:191], v[116:119]
    v_sub_u32_sdwa v173, v173, v235 clamp dst_sel:DWORD dst_unused:UNUSED_PAD src0_sel:DWORD src1_sel:WORD_0
    v_and_or_b32 v172, v125, s8, v172
    v_and_or_b32 v173, v127, s8, v173
    v_bfi_b32 v234, s9, v172, v234
    v_mfma_f32_16x16x32_bf16 v[128:131], v[92:95], v[188:191], v[128:131]
    ds_read_b128 v[184:187], v142 offset:24576
    v_bfi_b32 v235, s9, v173, v235
    ds_bpermute_b32 v232, v146, v232
    ds_bpermute_b32 v233, v146, v233
    ds_bpermute_b32 v234, v146, v234
    s_waitcnt lgkmcnt(9)
    v_mfma_f32_16x16x32_bf16 v[116:119], v[64:67], v[192:195], v[116:119]
    ds_bpermute_b32 v235, v146, v235
    v_mfma_f32_16x16x32_bf16 v[128:131], v[96:99], v[192:195], v[128:131]
    ds_read_b128 v[188:191], v143 offset:24576
    s_waitcnt lgkmcnt(10)
    v_mfma_f32_16x16x32_bf16 v[116:119], v[68:71], v[196:199], v[116:119]
    v_mfma_f32_16x16x32_bf16 v[128:131], v[100:103], v[196:199], v[128:131]
    ds_read_b128 v[192:195], v140 offset:24832
    s_waitcnt lgkmcnt(10)
    v_mfma_f32_16x16x32_bf16 v[116:119], v[72:75], v[200:203], v[116:119]
    v_mfma_f32_16x16x32_bf16 v[128:131], v[104:107], v[200:203], v[128:131]
    ds_read_b128 v[196:199], v141 offset:24832
    s_waitcnt lgkmcnt(10)
    v_mfma_f32_16x16x32_bf16 v[116:119], v[76:79], v[204:207], v[116:119]
    v_mfma_f32_16x16x32_bf16 v[128:131], v[108:111], v[204:207], v[128:131]
    ds_read_b128 v[200:203], v142 offset:24832
    s_waitcnt lgkmcnt(10)
    v_mfma_f32_16x16x32_bf16 v[120:123], v[48:51], v[176:179], 0
    v_mfma_f32_16x16x32_bf16 v[132:135], v[80:83], v[176:179], 0
    ds_read_b128 v[204:207], v143 offset:24832
    s_waitcnt lgkmcnt(10)
    v_mfma_f32_16x16x32_bf16 v[120:123], v[52:55], v[180:183], v[120:123]
    s_mov_b32 s3, 3216550459
    s_brev_b32 s8, 1
    s_mov_b32 s9, 0xffff0000
    v_cvt_pk_bf16_f32 v238, v128, v129
    v_mfma_f32_16x16x32_bf16 v[132:135], v[84:87], v[180:183], v[132:135]
    ds_read_b128 v[176:179], v140 offset:32768
    v_cvt_pk_bf16_f32 v239, v130, v131
    v_and_b32 v172, 0x7fffffff, v129
    v_and_b32 v173, 0x7fffffff, v131
    v_mul_f32 v116, s3, v116
    s_waitcnt lgkmcnt(10)
    v_mfma_f32_16x16x32_bf16 v[120:123], v[56:59], v[184:187], v[120:123]
    v_mul_f32 v117, s3, v117
    v_mul_f32 v118, s3, v118
    v_mul_f32 v119, s3, v119
    v_add_u32 v172, 0x8000, v172
    v_mfma_f32_16x16x32_bf16 v[132:135], v[88:91], v[184:187], v[132:135]
    ds_read_b128 v[180:183], v141 offset:32768
    v_add_u32 v173, 0x8000, v173
    v_cvt_pk_bf16_f32 v236, v116, v117
    v_cvt_pk_bf16_f32 v237, v118, v119
    v_sub_u32_sdwa v172, v172, v238 clamp dst_sel:DWORD dst_unused:UNUSED_PAD src0_sel:DWORD src1_sel:WORD_0
    s_waitcnt lgkmcnt(6)
    v_mfma_f32_16x16x32_bf16 v[120:123], v[60:63], v[188:191], v[120:123]
    v_sub_u32_sdwa v173, v173, v239 clamp dst_sel:DWORD dst_unused:UNUSED_PAD src0_sel:DWORD src1_sel:WORD_0
    v_and_or_b32 v172, v129, s8, v172
    v_and_or_b32 v173, v131, s8, v173
    v_bfi_b32 v238, s9, v172, v238
    v_mfma_f32_16x16x32_bf16 v[132:135], v[92:95], v[188:191], v[132:135]
    ds_read_b128 v[184:187], v142 offset:32768
    v_bfi_b32 v239, s9, v173, v239
    ds_bpermute_b32 v236, v146, v236
    ds_bpermute_b32 v237, v146, v237
    ds_bpermute_b32 v238, v146, v238
    s_waitcnt lgkmcnt(9)
    v_mfma_f32_16x16x32_bf16 v[120:123], v[64:67], v[192:195], v[120:123]
    ds_bpermute_b32 v239, v146, v239
    v_mfma_f32_16x16x32_bf16 v[132:135], v[96:99], v[192:195], v[132:135]
    ds_read_b128 v[188:191], v143 offset:32768
    s_waitcnt lgkmcnt(10)
    v_mfma_f32_16x16x32_bf16 v[120:123], v[68:71], v[196:199], v[120:123]
    v_mfma_f32_16x16x32_bf16 v[132:135], v[100:103], v[196:199], v[132:135]
    ds_read_b128 v[192:195], v140 offset:33024
    s_waitcnt lgkmcnt(10)
    v_mfma_f32_16x16x32_bf16 v[120:123], v[72:75], v[200:203], v[120:123]
    v_mfma_f32_16x16x32_bf16 v[132:135], v[104:107], v[200:203], v[132:135]
    ds_read_b128 v[196:199], v141 offset:33024
    s_waitcnt lgkmcnt(10)
    v_mfma_f32_16x16x32_bf16 v[120:123], v[76:79], v[204:207], v[120:123]
    v_mfma_f32_16x16x32_bf16 v[132:135], v[108:111], v[204:207], v[132:135]
    ds_read_b128 v[200:203], v142 offset:33024
    s_waitcnt lgkmcnt(10)
    v_mfma_f32_16x16x32_bf16 v[112:115], v[48:51], v[176:179], 0
    v_mfma_f32_16x16x32_bf16 v[124:127], v[80:83], v[176:179], 0
    ds_read_b128 v[204:207], v143 offset:33024
    s_waitcnt lgkmcnt(10)
    v_mfma_f32_16x16x32_bf16 v[112:115], v[52:55], v[180:183], v[112:115]
    s_mov_b32 s3, 3216550459
    s_brev_b32 s8, 1
    s_mov_b32 s9, 0xffff0000
    v_cvt_pk_bf16_f32 v242, v132, v133
    v_mfma_f32_16x16x32_bf16 v[124:127], v[84:87], v[180:183], v[124:127]
    v_cvt_pk_bf16_f32 v243, v134, v135
    v_and_b32 v172, 0x7fffffff, v133
    v_and_b32 v173, 0x7fffffff, v135
    v_mul_f32 v120, s3, v120
    s_waitcnt lgkmcnt(9)
    v_mfma_f32_16x16x32_bf16 v[112:115], v[56:59], v[184:187], v[112:115]
    v_mul_f32 v121, s3, v121
    v_mul_f32 v122, s3, v122
    v_mul_f32 v123, s3, v123
    v_add_u32 v172, 0x8000, v172
    v_mfma_f32_16x16x32_bf16 v[124:127], v[88:91], v[184:187], v[124:127]
    v_add_u32 v173, 0x8000, v173
    v_cvt_pk_bf16_f32 v240, v120, v121
    v_cvt_pk_bf16_f32 v241, v122, v123
    v_sub_u32_sdwa v172, v172, v242 clamp dst_sel:DWORD dst_unused:UNUSED_PAD src0_sel:DWORD src1_sel:WORD_0
    s_waitcnt lgkmcnt(4)
    v_mfma_f32_16x16x32_bf16 v[112:115], v[60:63], v[188:191], v[112:115]
    v_sub_u32_sdwa v173, v173, v243 clamp dst_sel:DWORD dst_unused:UNUSED_PAD src0_sel:DWORD src1_sel:WORD_0
    v_and_or_b32 v172, v133, s8, v172
    v_and_or_b32 v173, v135, s8, v173
    v_bfi_b32 v242, s9, v172, v242
    v_mfma_f32_16x16x32_bf16 v[124:127], v[92:95], v[188:191], v[124:127]
    v_bfi_b32 v243, s9, v173, v243
    ds_bpermute_b32 v240, v146, v240
    ds_bpermute_b32 v241, v146, v241
    ds_bpermute_b32 v242, v146, v242
    s_waitcnt lgkmcnt(6)
    v_mfma_f32_16x16x32_bf16 v[112:115], v[64:67], v[192:195], v[112:115]
    ds_bpermute_b32 v243, v146, v243
    v_mfma_f32_16x16x32_bf16 v[124:127], v[96:99], v[192:195], v[124:127]
    s_waitcnt lgkmcnt(6)
    v_mfma_f32_16x16x32_bf16 v[112:115], v[68:71], v[196:199], v[112:115]
    v_mfma_f32_16x16x32_bf16 v[124:127], v[100:103], v[196:199], v[124:127]
    s_waitcnt lgkmcnt(5)
    v_mfma_f32_16x16x32_bf16 v[112:115], v[72:75], v[200:203], v[112:115]
    v_mfma_f32_16x16x32_bf16 v[124:127], v[104:107], v[200:203], v[124:127]
    s_waitcnt lgkmcnt(4)
    v_mfma_f32_16x16x32_bf16 v[112:115], v[76:79], v[204:207], v[112:115]
    v_mfma_f32_16x16x32_bf16 v[124:127], v[108:111], v[204:207], v[124:127]
    s_nop 7
    s_mov_b32 s3, 3216550459
    s_brev_b32 s8, 1
    s_mov_b32 s9, 0xffff0000
    v_cvt_pk_bf16_f32 v246, v124, v125
    v_cvt_pk_bf16_f32 v247, v126, v127
    v_and_b32 v172, 0x7fffffff, v125
    v_and_b32 v173, 0x7fffffff, v127
    v_mul_f32 v112, s3, v112
    v_mul_f32 v113, s3, v113
    v_mul_f32 v114, s3, v114
    v_mul_f32 v115, s3, v115
    v_add_u32 v172, 0x8000, v172
    v_add_u32 v173, 0x8000, v173
    v_cvt_pk_bf16_f32 v244, v112, v113
    v_cvt_pk_bf16_f32 v245, v114, v115
    v_sub_u32_sdwa v172, v172, v246 clamp dst_sel:DWORD dst_unused:UNUSED_PAD src0_sel:DWORD src1_sel:WORD_0
    v_sub_u32_sdwa v173, v173, v247 clamp dst_sel:DWORD dst_unused:UNUSED_PAD src0_sel:DWORD src1_sel:WORD_0
    v_and_or_b32 v172, v125, s8, v172
    v_and_or_b32 v173, v127, s8, v173
    v_bfi_b32 v246, s9, v172, v246
    v_bfi_b32 v247, s9, v173, v247
    ds_bpermute_b32 v244, v146, v244
    ds_bpermute_b32 v245, v146, v245
    ds_bpermute_b32 v246, v146, v246
    ds_bpermute_b32 v247, v146, v247
    v_mov_b32 v10, 161616
    s_mov_b32 s3, 0x200000
.L15:
    ds_read_b32 v11, v10
    s_waitcnt lgkmcnt(0)
    v_readfirstlane_b32 s4, v11
    s_nop 3
    s_cmp_ge_u32 s4, 4
    s_cbranch_scc1 .L16
    s_sub_u32 s3, s3, 1
    s_cmp_lg_u32 s3, 0
    s_cbranch_scc1 .L15
.L16:
    v_bfe_u32 v4, v1, 3, 1
    v_and_b32 v5, 1, v2
    v_lshl_or_b32 v4, v5, 1, v4
    v_xor_b32 v4, s79, v4
    v_lshlrev_b32 v4, 5, v4
    v_lshl_add_u32 v4, v14, 3, v4
    v_bfe_u32 v5, v1, 2, 2
    v_lshl_add_u32 v5, v2, 3, v5
    v_lshl_add_u32 v4, v5, 7, v4
    v_add_u32 v136, 81920, v4
    v_add_u32 v137, 114688, v4
    ds_read_b64_tr_b16 v[48:49], v136 offset:0
    ds_read_b64_tr_b16 v[50:51], v136 offset:512
    ds_read_b64_tr_b16 v[52:53], v136 offset:4096
    ds_read_b64_tr_b16 v[54:55], v136 offset:4608
    ds_read_b64_tr_b16 v[56:57], v136 offset:8192
    ds_read_b64_tr_b16 v[58:59], v136 offset:8704
    ds_read_b64_tr_b16 v[60:61], v136 offset:12288
    ds_read_b64_tr_b16 v[62:63], v136 offset:12800
    ds_read_b64_tr_b16 v[64:65], v136 offset:16384
    ds_read_b64_tr_b16 v[66:67], v136 offset:16896
    ds_read_b64_tr_b16 v[68:69], v136 offset:20480
    ds_read_b64_tr_b16 v[70:71], v136 offset:20992
    s_waitcnt lgkmcnt(4)
    ds_read_b64_tr_b16 v[72:73], v136 offset:24576
    ds_read_b64_tr_b16 v[74:75], v136 offset:25088
    ds_read_b64_tr_b16 v[76:77], v136 offset:28672
    ds_read_b64_tr_b16 v[78:79], v136 offset:29184
    ds_read_b64_tr_b16 v[80:81], v137 offset:0
    ds_read_b64_tr_b16 v[82:83], v137 offset:512
    ds_read_b64_tr_b16 v[84:85], v137 offset:4096
    ds_read_b64_tr_b16 v[86:87], v137 offset:4608
    ds_read_b64_tr_b16 v[88:89], v137 offset:8192
    ds_read_b64_tr_b16 v[90:91], v137 offset:8704
    ds_read_b64_tr_b16 v[92:93], v137 offset:12288
    ds_read_b64_tr_b16 v[94:95], v137 offset:12800
    s_waitcnt lgkmcnt(4)
    ds_read_b64_tr_b16 v[96:97], v137 offset:16384
    ds_read_b64_tr_b16 v[98:99], v137 offset:16896
    ds_read_b64_tr_b16 v[100:101], v137 offset:20480
    ds_read_b64_tr_b16 v[102:103], v137 offset:20992
    ds_read_b64_tr_b16 v[104:105], v137 offset:24576
    ds_read_b64_tr_b16 v[106:107], v137 offset:25088
    ds_read_b64_tr_b16 v[108:109], v137 offset:28672
    ds_read_b64_tr_b16 v[110:111], v137 offset:29184
    s_waitcnt lgkmcnt(0)
    s_waitcnt lgkmcnt(0)
    v_mov_b32 v10, 161620
    v_mov_b32 v11, 1
    s_mov_b64 s[8:9], exec
    s_mov_b64 exec, 1
    ds_add_u32 v10, v11
    s_mov_b64 exec, s[8:9]
    v_mov_b32 v10, 161620
    s_mov_b32 s3, 0x200000
.L17:
    ds_read_b32 v11, v10
    s_waitcnt lgkmcnt(0)
    v_readfirstlane_b32 s4, v11
    s_nop 3
    s_cmp_ge_u32 s4, 4
    s_cbranch_scc1 .L18
    s_sub_u32 s3, s3, 1
    s_cmp_lg_u32 s3, 0
    s_cbranch_scc1 .L17
.L18:
    s_lshl_b32 s4, s79, 2
    v_add_u32 v4, s4, v2
    v_mul_u32_u24 v5, 136, v3
    v_lshl_add_u32 v144, v4, 1, v5
    v_add_u32 v144, 98304, v144
    v_lshl_add_u32 v145, v4, 3, v5
    v_add_u32 v145, 81920, v145
    ds_read_b128 v[176:179], v168 offset:0
    ds_read_b128 v[180:183], v169 offset:0
    ds_read_b128 v[184:187], v170 offset:0
    ds_read_b128 v[188:191], v171 offset:0
    ds_read_b128 v[192:195], v168 offset:256
    ds_read_b128 v[196:199], v169 offset:256
    ds_read_b128 v[200:203], v170 offset:256
    s_waitcnt lgkmcnt(6)
    v_mfma_f32_16x16x32_bf16 v[112:115], v[48:51], v[176:179], 0
    v_mfma_f32_16x16x32_bf16 v[16:19], v[80:83], v[176:179], 0
    ds_read_b128 v[204:207], v171 offset:256
    s_waitcnt lgkmcnt(6)
    v_mfma_f32_16x16x32_bf16 v[112:115], v[52:55], v[180:183], v[112:115]
    v_add_u32 v8, 48, v147
    v_add_u32 v9, s99, v8
    v_cmp_gt_u32 vcc, s81, v8
    v_lshl_add_u32 v9, v9, 8, v46
    v_mfma_f32_16x16x32_bf16 v[16:19], v[84:87], v[180:183], v[16:19]
    ds_read_b128 v[176:179], v168 offset:8192
    v_mov_b32 v8, 0x80000000
    v_cndmask_b32 v9, v8, v9, vcc
    buffer_store_dwordx4 v[220:223], v9, s[48:51], 0 offen sc1
    v_add_u32 v8, 64, v147
    s_waitcnt lgkmcnt(6)
    v_mfma_f32_16x16x32_bf16 v[112:115], v[56:59], v[184:187], v[112:115]
    v_add_u32 v9, s99, v8
    v_cmp_gt_u32 vcc, s81, v8
    v_lshl_add_u32 v9, v9, 8, v46
    v_mov_b32 v8, 0x80000000
    v_mfma_f32_16x16x32_bf16 v[16:19], v[88:91], v[184:187], v[16:19]
    ds_read_b128 v[180:183], v169 offset:8192
    v_cndmask_b32 v9, v8, v9, vcc
    buffer_store_dwordx4 v[224:227], v9, s[48:51], 0 offen sc1
    v_add_u32 v8, 80, v147
    v_add_u32 v9, s99, v8
    s_waitcnt lgkmcnt(6)
    v_mfma_f32_16x16x32_bf16 v[112:115], v[60:63], v[188:191], v[112:115]
    v_cmp_gt_u32 vcc, s81, v8
    v_lshl_add_u32 v9, v9, 8, v46
    v_mov_b32 v8, 0x80000000
    v_cndmask_b32 v9, v8, v9, vcc
    v_mfma_f32_16x16x32_bf16 v[16:19], v[92:95], v[188:191], v[16:19]
    ds_read_b128 v[184:187], v170 offset:8192
    buffer_store_dwordx4 v[228:231], v9, s[48:51], 0 offen sc1
    s_waitcnt lgkmcnt(6)
    v_mfma_f32_16x16x32_bf16 v[112:115], v[64:67], v[192:195], v[112:115]
    v_mfma_f32_16x16x32_bf16 v[16:19], v[96:99], v[192:195], v[16:19]
    ds_read_b128 v[188:191], v171 offset:8192
    s_waitcnt lgkmcnt(6)
    v_mfma_f32_16x16x32_bf16 v[112:115], v[68:71], v[196:199], v[112:115]
    v_mfma_f32_16x16x32_bf16 v[16:19], v[100:103], v[196:199], v[16:19]
    ds_read_b128 v[192:195], v168 offset:8448
    s_waitcnt lgkmcnt(6)
    v_mfma_f32_16x16x32_bf16 v[112:115], v[72:75], v[200:203], v[112:115]
    v_mfma_f32_16x16x32_bf16 v[16:19], v[104:107], v[200:203], v[16:19]
    ds_read_b128 v[196:199], v169 offset:8448
    s_waitcnt lgkmcnt(6)
    v_mfma_f32_16x16x32_bf16 v[112:115], v[76:79], v[204:207], v[112:115]
    v_mfma_f32_16x16x32_bf16 v[16:19], v[108:111], v[204:207], v[16:19]
    ds_read_b128 v[200:203], v170 offset:8448
    s_waitcnt lgkmcnt(6)
    v_mfma_f32_16x16x32_bf16 v[116:119], v[48:51], v[176:179], 0
    v_mfma_f32_16x16x32_bf16 v[20:23], v[80:83], v[176:179], 0
    ds_read_b128 v[204:207], v171 offset:8448
    s_waitcnt lgkmcnt(6)
    v_mfma_f32_16x16x32_bf16 v[116:119], v[52:55], v[180:183], v[116:119]
    s_mov_b32 s3, 3216550459
    v_mul_f32 v112, s3, v112
    v_mul_f32 v113, s3, v113
    v_mul_f32 v114, s3, v114
    v_mfma_f32_16x16x32_bf16 v[20:23], v[84:87], v[180:183], v[20:23]
    ds_read_b128 v[176:179], v168 offset:16384
    v_mul_f32 v115, s3, v115
    v_cvt_pk_bf16_f32 v4, v112, v113
    v_cvt_pk_bf16_f32 v5, v114, v115
    ds_write_b16 v144, v4 offset:0
    s_waitcnt lgkmcnt(7)
    v_mfma_f32_16x16x32_bf16 v[116:119], v[56:59], v[184:187], v[116:119]
    ds_write_b16_d16_hi v144, v4 offset:32
    ds_write_b16 v144, v5 offset:64
    ds_write_b16_d16_hi v144, v5 offset:96
    v_add_u32 v8, 96, v147
    v_mfma_f32_16x16x32_bf16 v[20:23], v[88:91], v[184:187], v[20:23]
    ds_read_b128 v[180:183], v169 offset:16384
    v_add_u32 v9, s99, v8
    v_cmp_gt_u32 vcc, s81, v8
    v_lshl_add_u32 v9, v9, 8, v46
    v_mov_b32 v8, 0x80000000
    s_waitcnt lgkmcnt(10)
    v_mfma_f32_16x16x32_bf16 v[116:119], v[60:63], v[188:191], v[116:119]
    v_cndmask_b32 v9, v8, v9, vcc
    buffer_store_dwordx4 v[232:235], v9, s[48:51], 0 offen sc1
    v_add_u32 v8, 112, v147
    v_add_u32 v9, s99, v8
    v_mfma_f32_16x16x32_bf16 v[20:23], v[92:95], v[188:191], v[20:23]
    ds_read_b128 v[184:187], v170 offset:16384
    v_cmp_gt_u32 vcc, s81, v8
    v_lshl_add_u32 v9, v9, 8, v46
    v_mov_b32 v8, 0x80000000
    v_cndmask_b32 v9, v8, v9, vcc
    s_waitcnt lgkmcnt(10)
    v_mfma_f32_16x16x32_bf16 v[116:119], v[64:67], v[192:195], v[116:119]
    buffer_store_dwordx4 v[236:239], v9, s[48:51], 0 offen sc1
    v_mfma_f32_16x16x32_bf16 v[20:23], v[96:99], v[192:195], v[20:23]
    ds_read_b128 v[188:191], v171 offset:16384
    s_waitcnt lgkmcnt(10)
    v_mfma_f32_16x16x32_bf16 v[116:119], v[68:71], v[196:199], v[116:119]
    v_mfma_f32_16x16x32_bf16 v[20:23], v[100:103], v[196:199], v[20:23]
    ds_read_b128 v[192:195], v168 offset:16640
    s_waitcnt lgkmcnt(10)
    v_mfma_f32_16x16x32_bf16 v[116:119], v[72:75], v[200:203], v[116:119]
    v_mfma_f32_16x16x32_bf16 v[20:23], v[104:107], v[200:203], v[20:23]
    ds_read_b128 v[196:199], v169 offset:16640
    s_waitcnt lgkmcnt(10)
    v_mfma_f32_16x16x32_bf16 v[116:119], v[76:79], v[204:207], v[116:119]
    v_mfma_f32_16x16x32_bf16 v[20:23], v[108:111], v[204:207], v[20:23]
    ds_read_b128 v[200:203], v170 offset:16640
    s_waitcnt lgkmcnt(10)
    v_mfma_f32_16x16x32_bf16 v[120:123], v[48:51], v[176:179], 0
    v_mfma_f32_16x16x32_bf16 v[24:27], v[80:83], v[176:179], 0
    ds_read_b128 v[204:207], v171 offset:16640
    s_waitcnt lgkmcnt(6)
    v_mfma_f32_16x16x32_bf16 v[120:123], v[52:55], v[180:183], v[120:123]
    s_mov_b32 s3, 3216550459
    v_mul_f32 v116, s3, v116
    v_mul_f32 v117, s3, v117
    v_mul_f32 v118, s3, v118
    v_mfma_f32_16x16x32_bf16 v[24:27], v[84:87], v[180:183], v[24:27]
    ds_read_b128 v[176:179], v168 offset:24576
    v_mul_f32 v119, s3, v119
    v_cvt_pk_bf16_f32 v4, v116, v117
    v_cvt_pk_bf16_f32 v5, v118, v119
    ds_write_b16 v144, v4 offset:2176
    s_waitcnt lgkmcnt(7)
    v_mfma_f32_16x16x32_bf16 v[120:123], v[56:59], v[184:187], v[120:123]
    ds_write_b16_d16_hi v144, v4 offset:2208
    ds_write_b16 v144, v5 offset:2240
    ds_write_b16_d16_hi v144, v5 offset:2272
    v_add_u32 v8, 128, v147
    v_mfma_f32_16x16x32_bf16 v[24:27], v[88:91], v[184:187], v[24:27]
    ds_read_b128 v[180:183], v169 offset:24576
    v_add_u32 v9, s99, v8
    v_cmp_gt_u32 vcc, s81, v8
    v_lshl_add_u32 v9, v9, 8, v46
    v_mov_b32 v8, 0x80000000
    s_waitcnt lgkmcnt(10)
    v_mfma_f32_16x16x32_bf16 v[120:123], v[60:63], v[188:191], v[120:123]
    v_cndmask_b32 v9, v8, v9, vcc
    buffer_store_dwordx4 v[240:243], v9, s[48:51], 0 offen sc1
    v_add_u32 v8, 144, v147
    v_add_u32 v9, s99, v8
    v_mfma_f32_16x16x32_bf16 v[24:27], v[92:95], v[188:191], v[24:27]
    ds_read_b128 v[184:187], v170 offset:24576
    v_cmp_gt_u32 vcc, s81, v8
    v_lshl_add_u32 v9, v9, 8, v46
    v_mov_b32 v8, 0x80000000
    v_cndmask_b32 v9, v8, v9, vcc
    s_waitcnt lgkmcnt(10)
    v_mfma_f32_16x16x32_bf16 v[120:123], v[64:67], v[192:195], v[120:123]
    buffer_store_dwordx4 v[244:247], v9, s[48:51], 0 offen sc1
    v_mov_b32 v248, 0x714a714a
    v_mov_b32 v249, 0x714a714a
    v_mov_b32 v250, 0
    v_mfma_f32_16x16x32_bf16 v[24:27], v[96:99], v[192:195], v[24:27]
    ds_read_b128 v[188:191], v171 offset:24576
    v_mov_b32 v251, 0
    s_add_u32 s5, s76, 10000
    s_lshl_b32 s5, s5, 8
    v_lshl_add_u32 v6, v0, 4, s5
    s_waitcnt lgkmcnt(10)
    v_mfma_f32_16x16x32_bf16 v[120:123], v[68:71], v[196:199], v[120:123]
    v_cmp_gt_u32 vcc, 16, v0
    v_mov_b32 v4, 0x80000000
    s_nop 0
    v_cndmask_b32 v6, v4, v6, vcc
    v_mfma_f32_16x16x32_bf16 v[24:27], v[100:103], v[196:199], v[24:27]
    ds_read_b128 v[192:195], v168 offset:24832
    buffer_store_dwordx4 v[248:251], v6, s[48:51], 0 offen sc1
    s_waitcnt lgkmcnt(10)
    v_mfma_f32_16x16x32_bf16 v[120:123], v[72:75], v[200:203], v[120:123]
    v_mfma_f32_16x16x32_bf16 v[24:27], v[104:107], v[200:203], v[24:27]
    ds_read_b128 v[196:199], v169 offset:24832
    s_waitcnt lgkmcnt(10)
    v_mfma_f32_16x16x32_bf16 v[120:123], v[76:79], v[204:207], v[120:123]
    v_mfma_f32_16x16x32_bf16 v[24:27], v[108:111], v[204:207], v[24:27]
    ds_read_b128 v[200:203], v170 offset:24832
    s_waitcnt lgkmcnt(10)
    v_mfma_f32_16x16x32_bf16 v[112:115], v[48:51], v[176:179], 0
    v_mfma_f32_16x16x32_bf16 v[28:31], v[80:83], v[176:179], 0
    ds_read_b128 v[204:207], v171 offset:24832
    s_waitcnt lgkmcnt(6)
    v_mfma_f32_16x16x32_bf16 v[112:115], v[52:55], v[180:183], v[112:115]
    s_mov_b32 s3, 3216550459
    v_mul_f32 v120, s3, v120
    v_mul_f32 v121, s3, v121
    v_mul_f32 v122, s3, v122
    v_mfma_f32_16x16x32_bf16 v[28:31], v[84:87], v[180:183], v[28:31]
    ds_read_b128 v[176:179], v168 offset:32768
    v_mul_f32 v123, s3, v123
    v_cvt_pk_bf16_f32 v4, v120, v121
    v_cvt_pk_bf16_f32 v5, v122, v123
    ds_write_b16 v144, v4 offset:4352
    s_waitcnt lgkmcnt(7)
    v_mfma_f32_16x16x32_bf16 v[112:115], v[56:59], v[184:187], v[112:115]
    ds_write_b16_d16_hi v144, v4 offset:4384
    ds_write_b16 v144, v5 offset:4416
    ds_write_b16_d16_hi v144, v5 offset:4448
    v_mfma_f32_16x16x32_bf16 v[28:31], v[88:91], v[184:187], v[28:31]
    ds_read_b128 v[180:183], v169 offset:32768
    s_waitcnt lgkmcnt(10)
    v_mfma_f32_16x16x32_bf16 v[112:115], v[60:63], v[188:191], v[112:115]
    v_mfma_f32_16x16x32_bf16 v[28:31], v[92:95], v[188:191], v[28:31]
    ds_read_b128 v[184:187], v170 offset:32768
    s_waitcnt lgkmcnt(10)
    v_mfma_f32_16x16x32_bf16 v[112:115], v[64:67], v[192:195], v[112:115]
    v_mfma_f32_16x16x32_bf16 v[28:31], v[96:99], v[192:195], v[28:31]
    ds_read_b128 v[188:191], v171 offset:32768
    s_waitcnt lgkmcnt(10)
    v_mfma_f32_16x16x32_bf16 v[112:115], v[68:71], v[196:199], v[112:115]
    v_mfma_f32_16x16x32_bf16 v[28:31], v[100:103], v[196:199], v[28:31]
    ds_read_b128 v[192:195], v168 offset:33024
    s_waitcnt lgkmcnt(10)
    v_mfma_f32_16x16x32_bf16 v[112:115], v[72:75], v[200:203], v[112:115]
    v_mfma_f32_16x16x32_bf16 v[28:31], v[104:107], v[200:203], v[28:31]
    ds_read_b128 v[196:199], v169 offset:33024
    s_waitcnt lgkmcnt(10)
    v_mfma_f32_16x16x32_bf16 v[112:115], v[76:79], v[204:207], v[112:115]
    v_mfma_f32_16x16x32_bf16 v[28:31], v[108:111], v[204:207], v[28:31]
    ds_read_b128 v[200:203], v170 offset:33024
    s_waitcnt lgkmcnt(10)
    v_mfma_f32_16x16x32_bf16 v[116:119], v[48:51], v[176:179], 0
    v_mfma_f32_16x16x32_bf16 v[32:35], v[80:83], v[176:179], 0
    ds_read_b128 v[204:207], v171 offset:33024
    s_waitcnt lgkmcnt(6)
    v_mfma_f32_16x16x32_bf16 v[116:119], v[52:55], v[180:183], v[116:119]
    s_mov_b32 s3, 3216550459
    v_mul_f32 v112, s3, v112
    v_mul_f32 v113, s3, v113
    v_mul_f32 v114, s3, v114
    v_mfma_f32_16x16x32_bf16 v[32:35], v[84:87], v[180:183], v[32:35]
    ds_read_b128 v[176:179], v140 offset:0
    v_mul_f32 v115, s3, v115
    v_cvt_pk_bf16_f32 v4, v112, v113
    v_cvt_pk_bf16_f32 v5, v114, v115
    ds_write_b16 v144, v4 offset:6528
    s_waitcnt lgkmcnt(7)
    v_mfma_f32_16x16x32_bf16 v[116:119], v[56:59], v[184:187], v[116:119]
    ds_write_b16_d16_hi v144, v4 offset:6560
    ds_write_b16 v144, v5 offset:6592
    ds_write_b16_d16_hi v144, v5 offset:6624
    v_mfma_f32_16x16x32_bf16 v[32:35], v[88:91], v[184:187], v[32:35]
    ds_read_b128 v[180:183], v141 offset:0
    s_waitcnt lgkmcnt(10)
    v_mfma_f32_16x16x32_bf16 v[116:119], v[60:63], v[188:191], v[116:119]
    v_mfma_f32_16x16x32_bf16 v[32:35], v[92:95], v[188:191], v[32:35]
    ds_read_b128 v[184:187], v142 offset:0
    s_waitcnt lgkmcnt(10)
    v_mfma_f32_16x16x32_bf16 v[116:119], v[64:67], v[192:195], v[116:119]
    v_mfma_f32_16x16x32_bf16 v[32:35], v[96:99], v[192:195], v[32:35]
    ds_read_b128 v[188:191], v143 offset:0
    s_waitcnt lgkmcnt(10)
    v_mfma_f32_16x16x32_bf16 v[116:119], v[68:71], v[196:199], v[116:119]
    v_mfma_f32_16x16x32_bf16 v[32:35], v[100:103], v[196:199], v[32:35]
    ds_read_b128 v[192:195], v140 offset:256
    s_waitcnt lgkmcnt(10)
    v_mfma_f32_16x16x32_bf16 v[116:119], v[72:75], v[200:203], v[116:119]
    v_mfma_f32_16x16x32_bf16 v[32:35], v[104:107], v[200:203], v[32:35]
    ds_read_b128 v[196:199], v141 offset:256
    s_waitcnt lgkmcnt(10)
    v_mfma_f32_16x16x32_bf16 v[116:119], v[76:79], v[204:207], v[116:119]
    v_mfma_f32_16x16x32_bf16 v[32:35], v[108:111], v[204:207], v[32:35]
    ds_read_b128 v[200:203], v142 offset:256
    s_waitcnt lgkmcnt(10)
    v_mfma_f32_16x16x32_bf16 v[120:123], v[48:51], v[176:179], 0
    v_mfma_f32_16x16x32_bf16 v[132:135], v[80:83], v[176:179], 0
    ds_read_b128 v[204:207], v143 offset:256
    s_waitcnt lgkmcnt(6)
    v_mfma_f32_16x16x32_bf16 v[120:123], v[52:55], v[180:183], v[120:123]
    s_mov_b32 s3, 3216550459
    v_mul_f32 v116, s3, v116
    v_mul_f32 v117, s3, v117
    v_mul_f32 v118, s3, v118
    v_mfma_f32_16x16x32_bf16 v[132:135], v[84:87], v[180:183], v[132:135]
    v_mul_f32 v119, s3, v119
    v_cvt_pk_bf16_f32 v4, v116, v117
    v_cvt_pk_bf16_f32 v5, v118, v119
    ds_write_b16 v144, v4 offset:8704
    s_waitcnt lgkmcnt(6)
    v_mfma_f32_16x16x32_bf16 v[120:123], v[56:59], v[184:187], v[120:123]
    ds_write_b16_d16_hi v144, v4 offset:8736
    ds_write_b16 v144, v5 offset:8768
    ds_write_b16_d16_hi v144, v5 offset:8800
    v_mfma_f32_16x16x32_bf16 v[132:135], v[88:91], v[184:187], v[132:135]
    s_waitcnt lgkmcnt(8)
    v_mfma_f32_16x16x32_bf16 v[120:123], v[60:63], v[188:191], v[120:123]
    v_mfma_f32_16x16x32_bf16 v[132:135], v[92:95], v[188:191], v[132:135]
    s_waitcnt lgkmcnt(7)
    v_mfma_f32_16x16x32_bf16 v[120:123], v[64:67], v[192:195], v[120:123]
    v_mfma_f32_16x16x32_bf16 v[132:135], v[96:99], v[192:195], v[132:135]
    s_waitcnt lgkmcnt(6)
    v_mfma_f32_16x16x32_bf16 v[120:123], v[68:71], v[196:199], v[120:123]
    v_mfma_f32_16x16x32_bf16 v[132:135], v[100:103], v[196:199], v[132:135]
    s_waitcnt lgkmcnt(5)
    v_mfma_f32_16x16x32_bf16 v[120:123], v[72:75], v[200:203], v[120:123]
    v_mfma_f32_16x16x32_bf16 v[132:135], v[104:107], v[200:203], v[132:135]
    s_waitcnt lgkmcnt(4)
    v_mfma_f32_16x16x32_bf16 v[120:123], v[76:79], v[204:207], v[120:123]
    v_mfma_f32_16x16x32_bf16 v[132:135], v[108:111], v[204:207], v[132:135]
    s_waitcnt vmcnt(0)
    v_mov_b32 v10, 161628
    v_mov_b32 v11, 1
    s_mov_b64 s[8:9], exec
    s_mov_b64 exec, 1
    ds_add_rtn_u32 v11, v10, v11
    s_waitcnt lgkmcnt(0)
    v_readfirstlane_b32 s4, v11
    s_mov_b64 exec, s[8:9]
    s_nop 2
    s_cmp_lg_u32 s4, 3
    s_cbranch_scc1 .L19
    s_and_b32 s4, s76, 7
    s_lshl_b32 s5, s77, 3
    s_add_u32 s4, s4, s5
    s_add_u32 s4, s4, 32
    v_readfirstlane_b32 s3, v47
    s_mov_b32 s5, 0x400000
.L20:
    s_cmp_lg_u32 s3, 0
    s_cbranch_scc1 .L21
    v_mov_b32 v47, 0
    global_load_dword v47, v47, s[36:37] sc1
    s_waitcnt vmcnt(0)
    v_readfirstlane_b32 s3, v47
    s_sub_u32 s5, s5, 1
    s_cmp_lg_u32 s5, 0
    s_cbranch_scc1 .L20
.L21:
    s_lshl_b32 s4, s4, 7
    v_mov_b32 v4, s4
    v_mov_b32 v5, 1
    s_mov_b64 s[8:9], exec
    s_mov_b64 exec, 1
    global_atomic_add v4, v5, s[56:57]
    s_mov_b64 exec, s[8:9]
.L19:
    ds_read_b128 v[176:179], v140 offset:8192
    ds_read_b128 v[180:183], v141 offset:8192
    ds_read_b128 v[184:187], v142 offset:8192
    ds_read_b128 v[188:191], v143 offset:8192
    ds_read_b128 v[192:195], v140 offset:8448
    ds_read_b128 v[196:199], v141 offset:8448
    ds_read_b128 v[200:203], v142 offset:8448
    s_waitcnt lgkmcnt(6)
    v_mfma_f32_16x16x32_bf16 v[112:115], v[48:51], v[176:179], 0
    v_mfma_f32_16x16x32_bf16 v[124:127], v[80:83], v[176:179], 0
    ds_read_b128 v[204:207], v143 offset:8448
    s_waitcnt lgkmcnt(6)
    v_mfma_f32_16x16x32_bf16 v[112:115], v[52:55], v[180:183], v[112:115]
    s_mov_b32 s3, 3216550459
    v_mul_f32 v120, s3, v120
    v_mul_f32 v121, s3, v121
    v_mul_f32 v122, s3, v122
    v_mfma_f32_16x16x32_bf16 v[124:127], v[84:87], v[180:183], v[124:127]
    ds_read_b128 v[176:179], v140 offset:16384
    v_mul_f32 v123, s3, v123
    v_cvt_pk_bf16_f32 v4, v120, v121
    v_cvt_pk_bf16_f32 v5, v122, v123
    ds_write_b16 v144, v4 offset:10880
    s_waitcnt lgkmcnt(7)
    v_mfma_f32_16x16x32_bf16 v[112:115], v[56:59], v[184:187], v[112:115]
    ds_write_b16_d16_hi v144, v4 offset:10912
    ds_write_b16 v144, v5 offset:10944
    ds_write_b16_d16_hi v144, v5 offset:10976
    v_cvt_pk_bf16_f32 v6, v132, v133
    v_mfma_f32_16x16x32_bf16 v[124:127], v[88:91], v[184:187], v[124:127]
    ds_read_b128 v[180:183], v141 offset:16384
    v_cvt_pk_bf16_f32 v7, v134, v135
    ds_write_b64 v145, v[6:7] offset:0
    s_waitcnt lgkmcnt(11)
    v_mfma_f32_16x16x32_bf16 v[112:115], v[60:63], v[188:191], v[112:115]
    v_mfma_f32_16x16x32_bf16 v[124:127], v[92:95], v[188:191], v[124:127]
    ds_read_b128 v[184:187], v142 offset:16384
    s_waitcnt lgkmcnt(11)
    v_mfma_f32_16x16x32_bf16 v[112:115], v[64:67], v[192:195], v[112:115]
    v_mfma_f32_16x16x32_bf16 v[124:127], v[96:99], v[192:195], v[124:127]
    ds_read_b128 v[188:191], v143 offset:16384
    s_waitcnt lgkmcnt(11)
    v_mfma_f32_16x16x32_bf16 v[112:115], v[68:71], v[196:199], v[112:115]
    v_mfma_f32_16x16x32_bf16 v[124:127], v[100:103], v[196:199], v[124:127]
    ds_read_b128 v[192:195], v140 offset:16640
    s_waitcnt lgkmcnt(11)
    v_mfma_f32_16x16x32_bf16 v[112:115], v[72:75], v[200:203], v[112:115]
    v_mfma_f32_16x16x32_bf16 v[124:127], v[104:107], v[200:203], v[124:127]
    ds_read_b128 v[196:199], v141 offset:16640
    s_waitcnt lgkmcnt(11)
    v_mfma_f32_16x16x32_bf16 v[112:115], v[76:79], v[204:207], v[112:115]
    v_mfma_f32_16x16x32_bf16 v[124:127], v[108:111], v[204:207], v[124:127]
    ds_read_b128 v[200:203], v142 offset:16640
    s_waitcnt lgkmcnt(11)
    v_mfma_f32_16x16x32_bf16 v[116:119], v[48:51], v[176:179], 0
    v_mfma_f32_16x16x32_bf16 v[128:131], v[80:83], v[176:179], 0
    ds_read_b128 v[204:207], v143 offset:16640
    s_waitcnt lgkmcnt(7)
    v_mfma_f32_16x16x32_bf16 v[116:119], v[52:55], v[180:183], v[116:119]
    s_mov_b32 s3, 3216550459
    v_mul_f32 v112, s3, v112
    v_mul_f32 v113, s3, v113
    v_mul_f32 v114, s3, v114
    v_mfma_f32_16x16x32_bf16 v[128:131], v[84:87], v[180:183], v[128:131]
    ds_read_b128 v[176:179], v140 offset:24576
    v_mul_f32 v115, s3, v115
    v_cvt_pk_bf16_f32 v4, v112, v113
    v_cvt_pk_bf16_f32 v5, v114, v115
    ds_write_b16 v144, v4 offset:13056
    s_waitcnt lgkmcnt(7)
    v_mfma_f32_16x16x32_bf16 v[116:119], v[56:59], v[184:187], v[116:119]
    ds_write_b16_d16_hi v144, v4 offset:13088
    ds_write_b16 v144, v5 offset:13120
    ds_write_b16_d16_hi v144, v5 offset:13152
    v_cvt_pk_bf16_f32 v6, v124, v125
    v_mfma_f32_16x16x32_bf16 v[128:131], v[88:91], v[184:187], v[128:131]
    ds_read_b128 v[180:183], v141 offset:24576
    v_cvt_pk_bf16_f32 v7, v126, v127
    ds_write_b64 v145, v[6:7] offset:2176
    s_waitcnt lgkmcnt(11)
    v_mfma_f32_16x16x32_bf16 v[116:119], v[60:63], v[188:191], v[116:119]
    v_mfma_f32_16x16x32_bf16 v[128:131], v[92:95], v[188:191], v[128:131]
    ds_read_b128 v[184:187], v142 offset:24576
    s_waitcnt lgkmcnt(11)
    v_mfma_f32_16x16x32_bf16 v[116:119], v[64:67], v[192:195], v[116:119]
    v_mfma_f32_16x16x32_bf16 v[128:131], v[96:99], v[192:195], v[128:131]
    ds_read_b128 v[188:191], v143 offset:24576
    s_waitcnt lgkmcnt(11)
    v_mfma_f32_16x16x32_bf16 v[116:119], v[68:71], v[196:199], v[116:119]
    v_mfma_f32_16x16x32_bf16 v[128:131], v[100:103], v[196:199], v[128:131]
    ds_read_b128 v[192:195], v140 offset:24832
    s_waitcnt lgkmcnt(11)
    v_mfma_f32_16x16x32_bf16 v[116:119], v[72:75], v[200:203], v[116:119]
    v_mfma_f32_16x16x32_bf16 v[128:131], v[104:107], v[200:203], v[128:131]
    ds_read_b128 v[196:199], v141 offset:24832
    s_waitcnt lgkmcnt(11)
    v_mfma_f32_16x16x32_bf16 v[116:119], v[76:79], v[204:207], v[116:119]
    v_mfma_f32_16x16x32_bf16 v[128:131], v[108:111], v[204:207], v[128:131]
    ds_read_b128 v[200:203], v142 offset:24832
    s_waitcnt lgkmcnt(11)
    v_mfma_f32_16x16x32_bf16 v[120:123], v[48:51], v[176:179], 0
    v_mfma_f32_16x16x32_bf16 v[132:135], v[80:83], v[176:179], 0
    ds_read_b128 v[204:207], v143 offset:24832
    s_waitcnt lgkmcnt(7)
    v_mfma_f32_16x16x32_bf16 v[120:123], v[52:55], v[180:183], v[120:123]
    s_mov_b32 s3, 3216550459
    v_mul_f32 v116, s3, v116
    v_mul_f32 v117, s3, v117
    v_mul_f32 v118, s3, v118
    v_mfma_f32_16x16x32_bf16 v[132:135], v[84:87], v[180:183], v[132:135]
    ds_read_b128 v[176:179], v140 offset:32768
    v_mul_f32 v119, s3, v119
    v_cvt_pk_bf16_f32 v4, v116, v117
    v_cvt_pk_bf16_f32 v5, v118, v119
    ds_write_b16 v144, v4 offset:15232
    s_waitcnt lgkmcnt(7)
    v_mfma_f32_16x16x32_bf16 v[120:123], v[56:59], v[184:187], v[120:123]
    ds_write_b16_d16_hi v144, v4 offset:15264
    ds_write_b16 v144, v5 offset:15296
    ds_write_b16_d16_hi v144, v5 offset:15328
    v_cvt_pk_bf16_f32 v6, v128, v129
    v_mfma_f32_16x16x32_bf16 v[132:135], v[88:91], v[184:187], v[132:135]
    ds_read_b128 v[180:183], v141 offset:32768
    v_cvt_pk_bf16_f32 v7, v130, v131
    ds_write_b64 v145, v[6:7] offset:4352
    s_waitcnt lgkmcnt(11)
    v_mfma_f32_16x16x32_bf16 v[120:123], v[60:63], v[188:191], v[120:123]
    v_mfma_f32_16x16x32_bf16 v[132:135], v[92:95], v[188:191], v[132:135]
    ds_read_b128 v[184:187], v142 offset:32768
    s_waitcnt lgkmcnt(11)
    v_mfma_f32_16x16x32_bf16 v[120:123], v[64:67], v[192:195], v[120:123]
    v_mfma_f32_16x16x32_bf16 v[132:135], v[96:99], v[192:195], v[132:135]
    ds_read_b128 v[188:191], v143 offset:32768
    s_waitcnt lgkmcnt(11)
    v_mfma_f32_16x16x32_bf16 v[120:123], v[68:71], v[196:199], v[120:123]
    v_mfma_f32_16x16x32_bf16 v[132:135], v[100:103], v[196:199], v[132:135]
    ds_read_b128 v[192:195], v140 offset:33024
    s_waitcnt lgkmcnt(11)
    v_mfma_f32_16x16x32_bf16 v[120:123], v[72:75], v[200:203], v[120:123]
    v_mfma_f32_16x16x32_bf16 v[132:135], v[104:107], v[200:203], v[132:135]
    ds_read_b128 v[196:199], v141 offset:33024
    s_waitcnt lgkmcnt(11)
    v_mfma_f32_16x16x32_bf16 v[120:123], v[76:79], v[204:207], v[120:123]
    v_mfma_f32_16x16x32_bf16 v[132:135], v[108:111], v[204:207], v[132:135]
    ds_read_b128 v[200:203], v142 offset:33024
    s_waitcnt lgkmcnt(11)
    v_mfma_f32_16x16x32_bf16 v[112:115], v[48:51], v[176:179], 0
    v_mfma_f32_16x16x32_bf16 v[124:127], v[80:83], v[176:179], 0
    ds_read_b128 v[204:207], v143 offset:33024
    s_waitcnt lgkmcnt(7)
    v_mfma_f32_16x16x32_bf16 v[112:115], v[52:55], v[180:183], v[112:115]
    s_mov_b32 s3, 3216550459
    v_mul_f32 v120, s3, v120
    v_mul_f32 v121, s3, v121
    v_mul_f32 v122, s3, v122
    v_mfma_f32_16x16x32_bf16 v[124:127], v[84:87], v[180:183], v[124:127]
    v_mul_f32 v123, s3, v123
    v_cvt_pk_bf16_f32 v4, v120, v121
    v_cvt_pk_bf16_f32 v5, v122, v123
    ds_write_b16 v144, v4 offset:17408
    s_waitcnt lgkmcnt(6)
    v_mfma_f32_16x16x32_bf16 v[112:115], v[56:59], v[184:187], v[112:115]
    ds_write_b16_d16_hi v144, v4 offset:17440
    ds_write_b16 v144, v5 offset:17472
    ds_write_b16_d16_hi v144, v5 offset:17504
    v_cvt_pk_bf16_f32 v6, v132, v133
    v_mfma_f32_16x16x32_bf16 v[124:127], v[88:91], v[184:187], v[124:127]
    v_cvt_pk_bf16_f32 v7, v134, v135
    ds_write_b64 v145, v[6:7] offset:6528
    s_waitcnt lgkmcnt(9)
    v_mfma_f32_16x16x32_bf16 v[112:115], v[60:63], v[188:191], v[112:115]
    v_mfma_f32_16x16x32_bf16 v[124:127], v[92:95], v[188:191], v[124:127]
    s_waitcnt lgkmcnt(8)
    v_mfma_f32_16x16x32_bf16 v[112:115], v[64:67], v[192:195], v[112:115]
    v_mfma_f32_16x16x32_bf16 v[124:127], v[96:99], v[192:195], v[124:127]
    s_waitcnt lgkmcnt(7)
    v_mfma_f32_16x16x32_bf16 v[112:115], v[68:71], v[196:199], v[112:115]
    v_mfma_f32_16x16x32_bf16 v[124:127], v[100:103], v[196:199], v[124:127]
    s_waitcnt lgkmcnt(6)
    v_mfma_f32_16x16x32_bf16 v[112:115], v[72:75], v[200:203], v[112:115]
    v_mfma_f32_16x16x32_bf16 v[124:127], v[104:107], v[200:203], v[124:127]
    s_waitcnt lgkmcnt(5)
    v_mfma_f32_16x16x32_bf16 v[112:115], v[76:79], v[204:207], v[112:115]
    v_mfma_f32_16x16x32_bf16 v[124:127], v[108:111], v[204:207], v[124:127]
    s_nop 7
    s_mov_b32 s3, 3216550459
    v_mul_f32 v112, s3, v112
    v_mul_f32 v113, s3, v113
    v_mul_f32 v114, s3, v114
    v_mul_f32 v115, s3, v115
    v_cvt_pk_bf16_f32 v4, v112, v113
    v_cvt_pk_bf16_f32 v5, v114, v115
    ds_write_b16 v144, v4 offset:19584
    ds_write_b16_d16_hi v144, v4 offset:19616
    ds_write_b16 v144, v5 offset:19648
    ds_write_b16_d16_hi v144, v5 offset:19680
    v_cvt_pk_bf16_f32 v6, v124, v125
    v_cvt_pk_bf16_f32 v7, v126, v127
    ds_write_b64 v145, v[6:7] offset:8704
    v_swap_b32 v17, v18
    v_swap_b32 v21, v22
    v_swap_b32 v25, v26
    v_swap_b32 v29, v30
    v_swap_b32 v33, v34
    s_lshl_b32 s3, s77, 3
    s_lshl_b32 s4, s79, 1
    s_add_u32 s3, s3, s4
    v_lshrrev_b32 v4, 1, v2
    v_add_u32 v4, s3, v4
    v_xor_b32 v4, v4, v3
    v_lshlrev_b32 v4, 4, v4
    v_and_b32 v5, 1, v2
    v_lshl_add_u32 v4, v5, 3, v4
    v_lshl_add_u32 v4, v15, 9, v4
    ds_read_b64 v[36:37], v4 offset:0
    ds_read_b64 v[38:39], v4 offset:8192
    ds_read_b64 v[40:41], v4 offset:16384
    ds_read_b64 v[42:43], v4 offset:24576
    ds_read_b64 v[44:45], v4 offset:32768
    s_waitcnt lgkmcnt(0)
    v_mov_b32 v10, 161624
    v_mov_b32 v11, 1
    s_mov_b64 s[8:9], exec
    s_mov_b64 exec, 1
    ds_add_u32 v10, v11
    s_mov_b64 exec, s[8:9]
    v_mov_b32 v10, 161644
    s_mov_b32 s3, 0x200000
.L22:
    ds_read_b32 v11, v10
    s_waitcnt lgkmcnt(0)
    v_readfirstlane_b32 s4, v11
    s_nop 3
    s_cmp_ge_u32 s4, 4
    s_cbranch_scc1 .L23
    s_sleep 1
    s_sub_u32 s3, s3, 1
    s_cmp_lg_u32 s3, 0
    s_cbranch_scc1 .L22
.L23:
    v_mul_u32_u24 v7, 3, v1
    v_lshlrev_b32 v9, 2, v7
    v_add_u32 v9, 158980, v9
    v_mov_b32 v11, 161600
    ds_read_b32 v4, v9
    ds_read_b32 v5, v9 offset:4
    ds_read_b32 v6, v9 offset:8
    ds_read_b32 v11, v11
    s_waitcnt lgkmcnt(0)
    v_readfirstlane_b32 s90, v11
    v_add_u32 v4, 3, v4
    v_add_u32 v10, 0, v7
    v_lshrrev_b32 v4, 2, v4
    v_cmp_gt_u32 vcc, s81, v10
    v_max_u32 v4, 1, v4
    s_nop 0
    v_cndmask_b32 v4, 0, v4, vcc
    v_add_u32 v5, 3, v5
    v_add_u32 v10, 1, v7
    v_lshrrev_b32 v5, 2, v5
    v_cmp_gt_u32 vcc, s81, v10
    v_max_u32 v5, 1, v5
    s_nop 0
    v_cndmask_b32 v5, 0, v5, vcc
    v_add_u32 v6, 3, v6
    v_add_u32 v10, 2, v7
    v_lshrrev_b32 v6, 2, v6
    v_cmp_gt_u32 vcc, s81, v10
    v_max_u32 v6, 1, v6
    s_nop 0
    v_cndmask_b32 v6, 0, v6, vcc
    v_add3_u32 v8, v4, v5, v6
    v_mov_b32 v10, v8
    s_nop 1
    v_add_u32_dpp v10, v10, v10 row_shr:1 row_mask:0xf bank_mask:0xf bound_ctrl:0
    s_nop 1
    v_add_u32_dpp v10, v10, v10 row_shr:2 row_mask:0xf bank_mask:0xf bound_ctrl:0
    s_nop 1
    v_add_u32_dpp v10, v10, v10 row_shr:4 row_mask:0xf bank_mask:0xf bound_ctrl:0
    s_nop 1
    v_add_u32_dpp v10, v10, v10 row_shr:8 row_mask:0xf bank_mask:0xf bound_ctrl:0
    s_nop 1
    v_add_u32_dpp v10, v10, v10 row_bcast:15 row_mask:0xa bank_mask:0xf
    s_nop 1
    v_add_u32_dpp v10, v10, v10 row_bcast:31 row_mask:0xc bank_mask:0xf
    s_nop 1
    v_readlane_b32 s84, v10, 63
    v_sub_u32 v10, v10, v8
    v_cmp_gt_u32 vcc, 54, v1
    s_add_u32 s82, s84, 31
    s_lshr_b32 s82, s82, 5
    s_and_saveexec_b64 s[8:9], vcc
    v_lshlrev_b32 v9, 2, v7
    v_add_u32 v9, 152832, v9
    s_mov_b32 s3, 120064
    v_mov_b32 v8, 0x10000
    v_lshl_add_u32 v11, v10, 4, s3
    ds_write_b32 v9, v11 offset:6804
    v_cmp_ne_u32 vcc, 0, v4
    v_lshl_or_b32 v11, v4, 16, v10
    v_add_u32 v10, v10, v4
    v_cndmask_b32 v11, v8, v11, vcc
    ds_write_b32 v9, v11 offset:7456
    v_lshl_add_u32 v11, v10, 4, s3
    ds_write_b32 v9, v11 offset:6808
    v_cmp_ne_u32 vcc, 0, v5
    v_lshl_or_b32 v11, v5, 16, v10
    v_add_u32 v10, v10, v5
    v_cndmask_b32 v11, v8, v11, vcc
    ds_write_b32 v9, v11 offset:7460
    v_lshl_add_u32 v11, v10, 4, s3
    ds_write_b32 v9, v11 offset:6812
    v_cmp_ne_u32 vcc, 0, v6
    v_lshl_or_b32 v11, v6, 16, v10
    v_add_u32 v10, v10, v6
    v_cndmask_b32 v11, v8, v11, vcc
    ds_write_b32 v9, v11 offset:7464
    s_mov_b64 exec, s[8:9]
    v_mov_b32 v5, s84
    v_mov_b32 v6, 161604
    ds_write_b32 v6, v5
    v_cvt_f32_u32 v4, s82
    s_nop 0
    v_rcp_f32 v4, v4
    s_waitcnt lgkmcnt(0)
    v_readfirstlane_b32 s83, v4
    s_cmp_gt_u32 s84, 1024
    s_cbranch_scc1 .L24
    v_mov_b32 v4, v0
    v_mov_b32 v8, 0
    s_mov_b32 s3, 152832
    v_min_u32 v232, 161, v4
    v_lshl_add_u32 v232, v232, 2, s3
    ds_read_b32 v5, v232 offset:7456
    v_cmp_gt_u32 vcc, s81, v4
    v_mul_u32_u24 v234, 17, v4
    v_add_u32 v234, 12288, v234
    v_lshlrev_b32 v235, 4, v4
    s_waitcnt lgkmcnt(0)
    v_and_b32 v6, 0xffff, v5
    v_lshrrev_b32 v7, 16, v5
    v_add3_u32 v9, v6, v7, -1
    v_cndmask_b32 v7, 0, v7, vcc
    v_cvt_f32_u32 v11, v6
    v_add_f32 v11, 0.5, v11
    v_mul_f32 v11, s83, v11
    v_cvt_u32_f32 v11, v11
    v_cvt_f32_u32 v10, v9
    v_add_f32 v10, 0.5, v10
    v_mul_f32 v10, s83, v10
    v_cvt_u32_f32 v10, v10
    v_sub_u32 v10, v10, v11
    v_add_u32 v233, 1, v11
    v_lshl_or_b32 v10, v10, 8, v233
    v_cmp_gt_u32 vcc, 160, v4
    v_mov_b32 v233, 262144
    s_nop 0
    v_cndmask_b32 v232, v233, v232, vcc
    ds_write_b32 v232, v10 offset:8128
    v_add_u32 v9, v6, v8
    v_cvt_f32_u32 v10, v9
    v_add_f32 v10, 0.5, v10
    v_mul_f32 v10, s83, v10
    v_cvt_u32_f32 v10, v10
    v_mul_lo_u32 v5, v10, s82
    v_sub_u32 v5, v9, v5
    s_mov_b64 s[10:11], exec
    s_mov_b32 s4, 2560
.L25:
    v_cmp_lt_u32 vcc, v8, v7
    s_and_b64 exec, exec, vcc
    s_cbranch_execz .L26
    v_lshl_add_u32 v232, v9, 1, s3
    v_lshl_add_u32 v233, v10, 4, s4
    v_cmp_gt_u32 vcc, v10, v11
    v_cmp_ne_u32 s[8:9], 0, v5
    ds_write_b16 v232, v234
    v_cndmask_b32 v233, v235, v233, vcc
    v_cmp_ne_u32 vcc, 0, v8
    ds_write_b16 v232, v233 offset:2048
    s_and_b64 vcc, vcc, s[8:9]
    v_mov_b32 v233, 0x3f80
    v_add_u32 v8, 1, v8
    v_cndmask_b32 v233, 0, v233, vcc
    v_add_u32 v9, 1, v9
    v_add_u32 v5, 1, v5
    ds_write_b16 v232, v233 offset:4096
    v_cmp_le_u32 vcc, s82, v5
    v_subrev_u32 v233, s82, v5
    s_nop 0
    v_cndmask_b32 v5, v5, v233, vcc
    v_cndmask_b32 v233, 0, 1, vcc
    v_add_u32 v10, v10, v233
    s_branch .L25
.L26:
    s_mov_b64 exec, s[10:11]
    s_waitcnt lgkmcnt(0)
.L24:
    s_branch .Ljoin8
.Lsgrp7:
    s_setprio 2
    s_mov_b32 s72, s22
    s_and_b32 s73, s23, 0xffff
    s_mov_b32 s74, 640000
    s_mov_b32 s75, 0x20000
    s_mov_b32 s64, s20
    s_and_b32 s65, s21, 0xffff
    s_mov_b32 s66, 640000
    s_mov_b32 s67, 0x20000
    s_sub_u32 s6, s78, 4
    s_mul_i32 s4, s6, 160
    s_mul_i32 s3, s2, 640
    s_add_u32 s3, s3, s4
    v_add_u32 v8, s3, v1
    v_lshlrev_b32 v8, 2, v8
    buffer_load_dword v48, v8, s[72:75], 0 offen offset:0
    buffer_load_dword v49, v8, s[72:75], 0 offen offset:256
    buffer_load_dword v50, v8, s[72:75], 0 offen offset:512
    buffer_load_dword v51, v8, s[64:67], 0 offen offset:0
    buffer_load_dword v52, v8, s[64:67], 0 offen offset:256
    buffer_load_dword v53, v8, s[64:67], 0 offen offset:512
    v_add_u32 v9, s4, v1
    s_cmp_lg_u32 s78, 6
    s_cbranch_scc1 .L27
    s_cmp_lg_u32 s2, 0
    s_cbranch_scc1 .L28
    v_lshlrev_b32 v4, 7, v1
    v_mov_b32 v5, 0
    global_store_dword v4, v5, s[56:57] sc1
    s_waitcnt vmcnt(0)
    v_mov_b32 v4, 0
    v_mov_b32 v5, 1
    s_mov_b64 s[8:9], exec
    s_mov_b64 exec, 1
    global_store_dword v4, v5, s[36:37] sc1
    s_mov_b64 exec, s[8:9]
.L28:
.L27:
    s_cmp_ge_u32 s2, 250
    s_cbranch_scc1 .L29
    s_mov_b32 s3, 53431
    s_movk_i32 s4, 157
    s_mov_b32 s5, 147456
    s_mov_b32 s6, 147968
    v_mov_b32 v11, 1
    v_mov_b32 v6, 262144
    v_cmp_gt_u32 s[10:11], 32, v1
    s_waitcnt vmcnt(3)
    v_mul_u32_u24 v54, s3, v48
    v_lshrrev_b32 v54, 23, v54
    v_lshl_add_u32 v4, v54, 2, s5
    ds_add_rtn_u32 v57, v4, v11
    v_mul_u32_u24 v55, s3, v49
    v_lshrrev_b32 v55, 23, v55
    v_lshl_add_u32 v4, v55, 2, s5
    ds_add_rtn_u32 v58, v4, v11
    v_mul_u32_u24 v56, s3, v50
    v_lshrrev_b32 v56, 23, v56
    v_lshl_add_u32 v4, v56, 2, s5
    v_cndmask_b32 v4, v6, v4, s[10:11]
    ds_add_rtn_u32 v59, v4, v11
    v_mul_u32_u24 v4, s4, v54
    v_lshl_add_u32 v54, v54, 7, s6
    v_sub_u32 v48, v48, v4
    v_add_u32 v4, 0, v9
    v_add_u32 v48, 1, v48
    v_lshl_or_b32 v48, v4, 22, v48
    v_mul_u32_u24 v4, s4, v55
    v_lshl_add_u32 v55, v55, 7, s6
    v_sub_u32 v49, v49, v4
    v_add_u32 v4, 64, v9
    v_add_u32 v49, 1, v49
    v_lshl_or_b32 v49, v4, 22, v49
    v_mul_u32_u24 v4, s4, v56
    v_lshl_add_u32 v56, v56, 7, s6
    v_sub_u32 v50, v50, v4
    v_add_u32 v4, 128, v9
    v_add_u32 v50, 1, v50
    v_lshl_or_b32 v50, v4, 22, v50
    s_waitcnt vmcnt(0) lgkmcnt(0)
    v_lshl_or_b32 v48, v51, 8, v48
    v_cmp_eq_u32 vcc, 31, v57
    v_and_b32 v4, 15, v57
    v_lshrrev_b32 v5, 4, v57
    v_cndmask_b32 v48, v48, v11, vcc
    v_cmp_gt_u32 vcc, 32, v57
    v_lshl_or_b32 v4, v4, 1, v5
    v_lshl_add_u32 v54, v4, 2, v54
    v_cndmask_b32 v54, v6, v54, vcc
    ds_write_b32 v54, v48
    v_lshl_or_b32 v49, v52, 8, v49
    v_cmp_eq_u32 vcc, 31, v58
    v_and_b32 v4, 15, v58
    v_lshrrev_b32 v5, 4, v58
    v_cndmask_b32 v49, v49, v11, vcc
    v_cmp_gt_u32 vcc, 32, v58
    v_lshl_or_b32 v4, v4, 1, v5
    v_lshl_add_u32 v55, v4, 2, v55
    v_cndmask_b32 v55, v6, v55, vcc
    ds_write_b32 v55, v49
    v_lshl_or_b32 v50, v53, 8, v50
    v_cmp_eq_u32 vcc, 31, v59
    v_and_b32 v4, 15, v59
    v_lshrrev_b32 v5, 4, v59
    v_cndmask_b32 v50, v50, v11, vcc
    v_cmp_gt_u32 vcc, 32, v59
    v_lshl_or_b32 v4, v4, 1, v5
    v_lshl_add_u32 v56, v4, 2, v56
    s_and_b64 vcc, vcc, s[10:11]
    s_nop 1
    v_cndmask_b32 v56, v6, v56, vcc
    ds_write_b32 v56, v50
.L29:
    s_waitcnt lgkmcnt(0)
    v_mov_b32 v10, 161632
    v_mov_b32 v11, 1
    s_mov_b64 s[8:9], exec
    s_mov_b64 exec, 1
    ds_add_u32 v10, v11
    s_mov_b64 exec, s[8:9]
    v_mov_b32 v10, 161632
    s_mov_b32 s3, 0x200000
.L30:
    ds_read_b32 v11, v10
    s_waitcnt lgkmcnt(0)
    v_readfirstlane_b32 s4, v11
    s_nop 3
    s_cmp_ge_u32 s4, 4
    s_cbranch_scc1 .L31
    s_sub_u32 s3, s3, 1
    s_cmp_lg_u32 s3, 0
    s_cbranch_scc1 .L30
.L31:
    s_sub_u32 s6, s78, 4
    s_lshl_b32 s3, s6, 11
    s_add_u32 s4, s3, 147968
    v_lshl_add_u32 v4, v1, 4, s4
    ds_read_b128 v[64:67], v4
    ds_read_b128 v[68:71], v4 offset:1024
    s_lshl_b32 s4, s2, 13
    s_add_u32 s3, s3, s4
    v_lshl_add_u32 v4, v1, 4, s3
    s_waitcnt lgkmcnt(0)
    buffer_store_dwordx4 v[64:67], v4, s[52:55], 0 offen sc1
    buffer_store_dwordx4 v[68:71], v4, s[52:55], 0 offen offset:1024 sc1
    v_mov_b32 v47, 0
    global_load_dword v47, v47, s[36:37] sc1
    s_waitcnt vmcnt(0)
    v_mov_b32 v10, 161636
    v_mov_b32 v11, 1
    s_mov_b64 s[8:9], exec
    s_mov_b64 exec, 1
    ds_add_rtn_u32 v11, v10, v11
    s_waitcnt lgkmcnt(0)
    v_readfirstlane_b32 s4, v11
    s_mov_b64 exec, s[8:9]
    s_nop 2
    s_cmp_lg_u32 s4, 3
    s_cbranch_scc1 .L32
    s_and_b32 s4, s2, 31
    v_readfirstlane_b32 s3, v47
    s_mov_b32 s5, 0x400000
.L33:
    s_cmp_lg_u32 s3, 0
    s_cbranch_scc1 .L34
    v_mov_b32 v47, 0
    global_load_dword v47, v47, s[36:37] sc1
    s_waitcnt vmcnt(0)
    v_readfirstlane_b32 s3, v47
    s_sub_u32 s5, s5, 1
    s_cmp_lg_u32 s5, 0
    s_cbranch_scc1 .L33
.L34:
    s_lshl_b32 s4, s4, 7
    v_mov_b32 v4, s4
    v_mov_b32 v5, 1
    s_mov_b64 s[8:9], exec
    s_mov_b64 exec, 1
    global_atomic_add v4, v5, s[56:57]
    s_mov_b64 exec, s[8:9]
.L32:
    s_setprio 0
    s_mov_b32 s72, s28
    s_and_b32 s73, s29, 0xffff
    s_mov_b32 s74, 8192
    s_mov_b32 s75, 0x20000
    v_lshlrev_b32 v4, 11, v2
    v_lshl_add_u32 v4, v3, 3, v4
    s_lshl_b32 s3, s77, 7
    v_add_u32 v4, s3, v4
    buffer_load_dwordx2 v[240:241], v4, s[72:75], 0 offen offset:0
    buffer_load_dwordx2 v[242:243], v4, s[72:75], 0 offen offset:512
    buffer_load_dwordx2 v[244:245], v4, s[72:75], 0 offen offset:1024
    buffer_load_dwordx2 v[246:247], v4, s[72:75], 0 offen offset:1536
    s_waitcnt vmcnt(0)
    s_mov_b32 s3, 3216550459
    v_lshlrev_b32 v176, 16, v240
    v_and_b32 v177, 0xffff0000, v240
    v_lshlrev_b32 v178, 16, v241
    v_and_b32 v179, 0xffff0000, v241
    v_lshlrev_b32 v180, 16, v242
    v_and_b32 v181, 0xffff0000, v242
    v_lshlrev_b32 v182, 16, v243
    v_and_b32 v183, 0xffff0000, v243
    v_lshlrev_b32 v184, 16, v244
    v_and_b32 v185, 0xffff0000, v244
    v_lshlrev_b32 v186, 16, v245
    v_and_b32 v187, 0xffff0000, v245
    v_lshlrev_b32 v188, 16, v246
    v_and_b32 v189, 0xffff0000, v246
    v_lshlrev_b32 v190, 16, v247
    v_and_b32 v191, 0xffff0000, v247
    v_mul_f32 v176, s3, v176
    v_mul_f32 v177, s3, v177
    v_mul_f32 v178, s3, v178
    v_mul_f32 v179, s3, v179
    v_mul_f32 v180, s3, v180
    v_mul_f32 v181, s3, v181
    v_mul_f32 v182, s3, v182
    v_mul_f32 v183, s3, v183
    v_mul_f32 v184, s3, v184
    v_mul_f32 v185, s3, v185
    v_mul_f32 v186, s3, v186
    v_mul_f32 v187, s3, v187
    v_mul_f32 v188, s3, v188
    v_mul_f32 v189, s3, v189
    v_mul_f32 v190, s3, v190
    v_mul_f32 v191, s3, v191
    v_cvt_pk_bf16_f32 v148, v176, v180
    v_cvt_pk_bf16_f32 v149, v184, v188
    v_cvt_pk_bf16_f32 v152, v177, v181
    v_cvt_pk_bf16_f32 v153, v185, v189
    v_cvt_pk_bf16_f32 v156, v178, v182
    v_cvt_pk_bf16_f32 v157, v186, v190
    v_cvt_pk_bf16_f32 v160, v179, v183
    v_cvt_pk_bf16_f32 v161, v187, v191
    v_mov_b32 v10, 161612
    s_mov_b32 s3, 0x200000
.L35:
    ds_read_b32 v11, v10
    s_waitcnt lgkmcnt(0)
    v_readfirstlane_b32 s4, v11
    s_nop 3
    s_cmp_ge_u32 s4, 4
    s_cbranch_scc1 .L36
    s_sleep 1
    s_sub_u32 s3, s3, 1
    s_cmp_lg_u32 s3, 0
    s_cbranch_scc1 .L35
.L36:
    s_mov_b32 s64, s24
    s_and_b32 s65, s25, 0xffff
    s_mov_b32 s66, 131072
    s_mov_b32 s67, 0x20000
    s_mov_b32 s68, s30
    s_and_b32 s69, s31, 0xffff
    s_mov_b32 s70, 131072
    s_mov_b32 s71, 0x20000
    v_lshrrev_b32 v6, 4, v1
    v_and_b32 v6, 1, v6
    s_and_b32 s3, s79, 1
    s_lshl_b32 s3, s3, 1
    v_or_b32 v6, s3, v6
    v_bfe_u32 v7, v1, 1, 2
    v_xor_b32 v6, v6, v7
    v_lshlrev_b32 v6, 5, v6
    v_and_b32 v7, 1, v1
    v_lshl_add_u32 v6, v7, 4, v6
    v_lshrrev_b32 v7, 3, v1
    s_lshl_b32 s3, s79, 3
    v_add_u32 v7, s3, v7
    v_lshl_add_u32 v6, v7, 9, v6
    s_lshl_b32 s3, s77, 7
    v_add_u32 v6, s3, v6
    s_lshl_b32 s4, s79, 10
    s_add_u32 s4, s4, 81920
    s_mov_b32 s5, 0
    s_mov_b32 m0, s4
    s_add_u32 s4, s4, 4096
    buffer_load_dwordx4 v6, s[64:67], s5 offen lds
    s_add_u32 s5, s5, 16384
    s_mov_b32 m0, s4
    s_add_u32 s4, s4, 4096
    buffer_load_dwordx4 v6, s[64:67], s5 offen lds
    s_add_u32 s5, s5, 16384
    s_mov_b32 m0, s4
    s_add_u32 s4, s4, 4096
    buffer_load_dwordx4 v6, s[64:67], s5 offen lds
    s_add_u32 s5, s5, 16384
    s_mov_b32 m0, s4
    s_add_u32 s4, s4, 4096
    buffer_load_dwordx4 v6, s[64:67], s5 offen lds
    s_add_u32 s5, s5, 16384
    s_mov_b32 m0, s4
    s_add_u32 s4, s4, 4096
    buffer_load_dwordx4 v6, s[64:67], s5 offen lds
    s_add_u32 s5, s5, 16384
    s_mov_b32 m0, s4
    s_add_u32 s4, s4, 4096
    buffer_load_dwordx4 v6, s[64:67], s5 offen lds
    s_add_u32 s5, s5, 16384
    s_mov_b32 m0, s4
    s_add_u32 s4, s4, 4096
    buffer_load_dwordx4 v6, s[64:67], s5 offen lds
    s_add_u32 s5, s5, 16384
    s_mov_b32 m0, s4
    s_add_u32 s4, s4, 4096
    buffer_load_dwordx4 v6, s[64:67], s5 offen lds
    s_lshl_b32 s4, s79, 10
    s_add_u32 s4, s4, 114688
    s_mov_b32 s5, 0
    s_mov_b32 m0, s4
    s_add_u32 s4, s4, 4096
    buffer_load_dwordx4 v6, s[68:71], s5 offen lds
    s_add_u32 s5, s5, 16384
    s_mov_b32 m0, s4
    s_add_u32 s4, s4, 4096
    buffer_load_dwordx4 v6, s[68:71], s5 offen lds
    s_add_u32 s5, s5, 16384
    s_mov_b32 m0, s4
    s_add_u32 s4, s4, 4096
    buffer_load_dwordx4 v6, s[68:71], s5 offen lds
    s_add_u32 s5, s5, 16384
    s_mov_b32 m0, s4
    s_add_u32 s4, s4, 4096
    buffer_load_dwordx4 v6, s[68:71], s5 offen lds
    s_add_u32 s5, s5, 16384
    s_mov_b32 m0, s4
    s_add_u32 s4, s4, 4096
    buffer_load_dwordx4 v6, s[68:71], s5 offen lds
    s_add_u32 s5, s5, 16384
    s_mov_b32 m0, s4
    s_add_u32 s4, s4, 4096
    buffer_load_dwordx4 v6, s[68:71], s5 offen lds
    s_add_u32 s5, s5, 16384
    s_mov_b32 m0, s4
    s_add_u32 s4, s4, 4096
    buffer_load_dwordx4 v6, s[68:71], s5 offen lds
    s_add_u32 s5, s5, 16384
    s_mov_b32 m0, s4
    s_add_u32 s4, s4, 4096
    buffer_load_dwordx4 v6, s[68:71], s5 offen lds
    s_lshl_b32 s3, s77, 3
    s_lshl_b32 s4, s79, 1
    s_add_u32 s3, s3, s4
    v_lshrrev_b32 v4, 1, v2
    v_add_u32 v4, s3, v4
    v_xor_b32 v4, v4, v3
    v_lshlrev_b32 v4, 4, v4
    v_and_b32 v5, 1, v2
    v_lshl_add_u32 v4, v5, 3, v4
    v_lshl_add_u32 v4, v15, 9, v4
    ds_read_b64 v[36:37], v4 offset:0
    ds_read_b64 v[38:39], v4 offset:8192
    ds_read_b64 v[40:41], v4 offset:16384
    ds_read_b64 v[42:43], v4 offset:24576
    ds_read_b64 v[44:45], v4 offset:32768
    s_cmp_lg_u32 s78, 7
    s_cbranch_scc1 .L37
    v_add_u32 v4, 0, v1
    v_readfirstlane_b32 s3, v47
    s_mov_b32 s5, 0x400000
.L40:
    s_cmp_lg_u32 s3, 0
    s_cbranch_scc1 .L41
    v_mov_b32 v47, 0
    global_load_dword v47, v47, s[36:37] sc1
    s_waitcnt vmcnt(0)
    v_readfirstlane_b32 s3, v47
    s_sub_u32 s5, s5, 1
    s_cmp_lg_u32 s5, 0
    s_cbranch_scc1 .L40
.L41:
    v_lshlrev_b32 v4, 7, v4
    v_cmp_gt_u32 vcc, 32, v1
    s_and_saveexec_b64 s[8:9], vcc
    s_mov_b32 s3, 0x40000
.L38:
    global_load_dword v5, v4, s[56:57] sc1
    s_waitcnt vmcnt(0)
    v_cmp_gt_u32 vcc, 8, v5
    s_nop 1
    s_cmp_eq_u64 vcc, 0
    s_cbranch_scc1 .L39
    s_sleep 1
    s_sub_u32 s3, s3, 1
    s_cmp_lg_u32 s3, 0
    s_cbranch_scc1 .L38
.L39:
    s_mov_b64 exec, s[8:9]
    v_mov_b32 v10, 161640
    v_mov_b32 v11, 1
    s_mov_b64 s[8:9], exec
    s_mov_b64 exec, 1
    ds_add_u32 v10, v11
    s_mov_b64 exec, s[8:9]
.L37:
    v_mov_b32 v10, 161640
    s_mov_b32 s3, 0x200000
.L42:
    ds_read_b32 v11, v10
    s_waitcnt lgkmcnt(0)
    v_readfirstlane_b32 s4, v11
    s_nop 3
    s_cmp_ge_u32 s4, 1
    s_cbranch_scc1 .L43
    s_sleep 1
    s_sub_u32 s3, s3, 1
    s_cmp_lg_u32 s3, 0
    s_cbranch_scc1 .L42
.L43:
    s_sub_u32 s6, s78, 4
    s_lshl_b32 s3, s6, 6
    v_add_u32 v4, s3, v2
    s_movk_i32 s5, 640
    v_mul_lo_u32 v212, v4, s5
    s_lshl_b32 s4, s76, 7
    v_lshl_add_u32 v5, v4, 13, s4
    v_lshl_add_u32 v5, v3, 3, v5
    s_mov_b32 s5, 0
    buffer_load_dwordx2 v[48:49], v5, s[52:55], s5 offen sc1
    s_add_u32 s5, s5, 32768
    buffer_load_dwordx2 v[50:51], v5, s[52:55], s5 offen sc1
    s_add_u32 s5, s5, 32768
    buffer_load_dwordx2 v[52:53], v5, s[52:55], s5 offen sc1
    s_add_u32 s5, s5, 32768
    buffer_load_dwordx2 v[54:55], v5, s[52:55], s5 offen sc1
    s_add_u32 s5, s5, 32768
    buffer_load_dwordx2 v[56:57], v5, s[52:55], s5 offen sc1
    s_add_u32 s5, s5, 32768
    buffer_load_dwordx2 v[58:59], v5, s[52:55], s5 offen sc1
    s_add_u32 s5, s5, 32768
    buffer_load_dwordx2 v[60:61], v5, s[52:55], s5 offen sc1
    s_add_u32 s5, s5, 32768
    buffer_load_dwordx2 v[62:63], v5, s[52:55], s5 offen sc1
    s_add_u32 s5, s5, 32768
    buffer_load_dwordx2 v[64:65], v5, s[52:55], s5 offen sc1
    s_add_u32 s5, s5, 32768
    buffer_load_dwordx2 v[66:67], v5, s[52:55], s5 offen sc1
    s_add_u32 s5, s5, 32768
    buffer_load_dwordx2 v[68:69], v5, s[52:55], s5 offen sc1
    s_add_u32 s5, s5, 32768
    buffer_load_dwordx2 v[70:71], v5, s[52:55], s5 offen sc1
    s_add_u32 s5, s5, 32768
    buffer_load_dwordx2 v[72:73], v5, s[52:55], s5 offen sc1
    s_add_u32 s5, s5, 32768
    buffer_load_dwordx2 v[74:75], v5, s[52:55], s5 offen sc1
    s_add_u32 s5, s5, 32768
    buffer_load_dwordx2 v[76:77], v5, s[52:55], s5 offen sc1
    s_add_u32 s5, s5, 32768
    buffer_load_dwordx2 v[78:79], v5, s[52:55], s5 offen sc1
    s_mul_i32 s3, s2, 20480
    v_subrev_u32 v4, 256, v0
    v_lshlrev_b32 v4, 4, v4
    v_add_u32 v4, s3, v4
    s_mov_b32 s5, 0
    buffer_load_dwordx4 v[192:195], v4, s[44:47], s5 offen
    s_add_u32 s5, s5, 4096
    buffer_load_dwordx4 v[192:195], v4, s[44:47], s5 offen
    s_add_u32 s5, s5, 4096
    buffer_load_dwordx4 v[192:195], v4, s[44:47], s5 offen
    s_add_u32 s5, s5, 4096
    buffer_load_dwordx4 v[192:195], v4, s[44:47], s5 offen
    s_add_u32 s5, s5, 4096
    buffer_load_dwordx4 v[192:195], v4, s[44:47], s5 offen
    s_waitcnt vmcnt(21)
    v_mov_b32 v10, 161616
    v_mov_b32 v11, 1
    s_mov_b64 s[8:9], exec
    s_mov_b64 exec, 1
    ds_add_u32 v10, v11
    s_mov_b64 exec, s[8:9]
    v_mov_b32 v10, 161620
    s_mov_b32 s3, 0x200000
.L44:
    ds_read_b32 v11, v10
    s_waitcnt lgkmcnt(0)
    v_readfirstlane_b32 s4, v11
    s_nop 3
    s_cmp_ge_u32 s4, 4
    s_cbranch_scc1 .L45
    s_sleep 1
    s_sub_u32 s3, s3, 1
    s_cmp_lg_u32 s3, 0
    s_cbranch_scc1 .L44
.L45:
    v_subrev_u32 v174, 256, v0
    v_lshlrev_b32 v4, 4, v174
    v_add_u32 v176, 10000, v1
    v_lshlrev_b32 v176, 8, v176
    v_mov_b32 v177, v176
    v_mov_b32 v178, v176
    v_mov_b32 v179, v176
    v_mov_b32 v180, 0x07fffff8
    v_mov_b32 v181, 0x07fffff8
    v_mov_b32 v182, 0x07fffff8
    v_mov_b32 v183, 0x07fffff8
    v_add_u32 v5, 120064, v4
    ds_write_b128 v5, v[176:179] offset:0
    ds_write_b128 v5, v[176:179] offset:4096
    ds_write_b128 v5, v[176:179] offset:8192
    ds_write_b128 v5, v[176:179] offset:12288
    ds_write_b128 v5, v[180:183] offset:16384
    ds_write_b128 v5, v[180:183] offset:20480
    ds_write_b128 v5, v[180:183] offset:24576
    ds_write_b128 v5, v[180:183] offset:28672
    v_add_u32 v5, 152832, v4
    v_mov_b32 v184, 805318656
    v_mov_b32 v185, 167774720
    v_cmp_gt_u32 vcc, 128, v174
    s_nop 1
    v_cndmask_b32 v184, v185, v184, vcc
    v_mov_b32 v185, v184
    v_mov_b32 v186, v184
    v_mov_b32 v187, v184
    ds_write_b128 v5, v[184:187]
    v_mov_b32 v176, 0
    v_mov_b32 v177, 0
    v_mov_b32 v178, 0
    v_mov_b32 v179, 0
    s_and_saveexec_b64 s[8:9], vcc
    ds_write_b128 v5, v[176:179] offset:4096
    s_mov_b64 exec, s[8:9]
    s_waitcnt vmcnt(5)
    v_mov_b32 v11, 1
    s_mov_b32 s3, 158976
    v_and_b32 v96, 0xff, v48
    v_lshl_add_u32 v96, v96, 2, s3
    v_cmpx_ne_u32 vcc, 0, v48
    ds_add_rtn_u32 v80, v96, v11
    s_mov_b64 exec, -1
    v_and_b32 v97, 0xff, v50
    v_lshl_add_u32 v97, v97, 2, s3
    v_cmpx_ne_u32 vcc, 0, v50
    ds_add_rtn_u32 v81, v97, v11
    s_mov_b64 exec, -1
    v_and_b32 v98, 0xff, v52
    v_lshl_add_u32 v98, v98, 2, s3
    v_cmpx_ne_u32 vcc, 0, v52
    ds_add_rtn_u32 v82, v98, v11
    s_mov_b64 exec, -1
    v_and_b32 v99, 0xff, v54
    v_lshl_add_u32 v99, v99, 2, s3
    v_cmpx_ne_u32 vcc, 0, v54
    ds_add_rtn_u32 v83, v99, v11
    s_mov_b64 exec, -1
    v_and_b32 v100, 0xff, v56
    v_lshl_add_u32 v100, v100, 2, s3
    v_cmpx_ne_u32 vcc, 0, v56
    ds_add_rtn_u32 v84, v100, v11
    s_mov_b64 exec, -1
    v_and_b32 v101, 0xff, v58
    v_lshl_add_u32 v101, v101, 2, s3
    v_cmpx_ne_u32 vcc, 0, v58
    ds_add_rtn_u32 v85, v101, v11
    s_mov_b64 exec, -1
    v_and_b32 v102, 0xff, v60
    v_lshl_add_u32 v102, v102, 2, s3
    v_cmpx_ne_u32 vcc, 0, v60
    ds_add_rtn_u32 v86, v102, v11
    s_mov_b64 exec, -1
    v_and_b32 v103, 0xff, v62
    v_lshl_add_u32 v103, v103, 2, s3
    v_cmpx_ne_u32 vcc, 0, v62
    ds_add_rtn_u32 v87, v103, v11
    s_mov_b64 exec, -1
    v_and_b32 v104, 0xff, v64
    v_lshl_add_u32 v104, v104, 2, s3
    v_cmpx_ne_u32 vcc, 0, v64
    ds_add_rtn_u32 v88, v104, v11
    s_mov_b64 exec, -1
    v_and_b32 v105, 0xff, v66
    v_lshl_add_u32 v105, v105, 2, s3
    v_cmpx_ne_u32 vcc, 0, v66
    ds_add_rtn_u32 v89, v105, v11
    s_mov_b64 exec, -1
    v_and_b32 v106, 0xff, v68
    v_lshl_add_u32 v106, v106, 2, s3
    v_cmpx_ne_u32 vcc, 0, v68
    ds_add_rtn_u32 v90, v106, v11
    s_mov_b64 exec, -1
    v_and_b32 v107, 0xff, v70
    v_lshl_add_u32 v107, v107, 2, s3
    v_cmpx_ne_u32 vcc, 0, v70
    ds_add_rtn_u32 v91, v107, v11
    s_mov_b64 exec, -1
    v_and_b32 v108, 0xff, v72
    v_lshl_add_u32 v108, v108, 2, s3
    v_cmpx_ne_u32 vcc, 0, v72
    ds_add_rtn_u32 v92, v108, v11
    s_mov_b64 exec, -1
    v_and_b32 v109, 0xff, v74
    v_lshl_add_u32 v109, v109, 2, s3
    v_cmpx_ne_u32 vcc, 0, v74
    ds_add_rtn_u32 v93, v109, v11
    s_mov_b64 exec, -1
    v_and_b32 v110, 0xff, v76
    v_lshl_add_u32 v110, v110, 2, s3
    v_cmpx_ne_u32 vcc, 0, v76
    ds_add_rtn_u32 v94, v110, v11
    s_mov_b64 exec, -1
    v_and_b32 v111, 0xff, v78
    v_lshl_add_u32 v111, v111, 2, s3
    v_cmpx_ne_u32 vcc, 0, v78
    ds_add_rtn_u32 v95, v111, v11
    s_mov_b64 exec, -1
    s_movk_i32 s4, 0
    v_lshrrev_b32 v112, 22, v48
    v_add3_u32 v112, v112, v212, s4
    s_movk_i32 s4, 2560
    v_lshrrev_b32 v113, 22, v50
    v_add3_u32 v113, v113, v212, s4
    s_movk_i32 s4, 5120
    v_lshrrev_b32 v114, 22, v52
    v_add3_u32 v114, v114, v212, s4
    s_movk_i32 s4, 7680
    v_lshrrev_b32 v115, 22, v54
    v_add3_u32 v115, v115, v212, s4
    s_movk_i32 s4, 10240
    v_lshrrev_b32 v116, 22, v56
    v_add3_u32 v116, v116, v212, s4
    s_movk_i32 s4, 12800
    v_lshrrev_b32 v117, 22, v58
    v_add3_u32 v117, v117, v212, s4
    s_movk_i32 s4, 15360
    v_lshrrev_b32 v118, 22, v60
    v_add3_u32 v118, v118, v212, s4
    s_movk_i32 s4, 17920
    v_lshrrev_b32 v119, 22, v62
    v_add3_u32 v119, v119, v212, s4
    s_movk_i32 s4, 20480
    v_lshrrev_b32 v120, 22, v64
    v_add3_u32 v120, v120, v212, s4
    s_movk_i32 s4, 23040
    v_lshrrev_b32 v121, 22, v66
    v_add3_u32 v121, v121, v212, s4
    s_movk_i32 s4, 25600
    v_lshrrev_b32 v122, 22, v68
    v_add3_u32 v122, v122, v212, s4
    s_movk_i32 s4, 28160
    v_lshrrev_b32 v123, 22, v70
    v_add3_u32 v123, v123, v212, s4
    s_movk_i32 s4, 30720
    v_lshrrev_b32 v124, 22, v72
    v_add3_u32 v124, v124, v212, s4
    s_mov_b32 s4, 33280
    v_lshrrev_b32 v125, 22, v74
    v_add3_u32 v125, v125, v212, s4
    s_mov_b32 s4, 35840
    v_lshrrev_b32 v126, 22, v76
    v_add3_u32 v126, v126, v212, s4
    s_mov_b32 s4, 38400
    v_lshrrev_b32 v127, 22, v78
    v_add3_u32 v127, v127, v212, s4
    v_or_b32 v5, v49, v51
    v_or3_b32 v5, v5, v53, v55
    v_or3_b32 v5, v5, v57, v59
    v_or3_b32 v5, v5, v61, v63
    v_or3_b32 v5, v5, v65, v67
    v_or3_b32 v5, v5, v69, v71
    v_or3_b32 v5, v5, v73, v75
    v_or3_b32 v5, v5, v77, v79
    v_cmp_ne_u32 vcc, 0, v5
    s_nop 1
    s_cmp_eq_u64 vcc, 0
    s_cselect_b32 s6, 0, 1
    s_mov_b32 s85, s6
    s_cbranch_scc1 .L46
    v_cmp_eq_u32 s[10:11], 15, v3
    v_mov_b32 v6, 161600
    s_nop 0
    v_cndmask_b32 v5, 0, v5, s[10:11]
    ds_max_u32 v6, v5
    v_cmp_ne_u32 vcc, 0, v49
    s_and_saveexec_b64 s[8:9], vcc
    s_cbranch_execz .L47
    v_and_b32 v4, 0xff, v49
    v_lshl_add_u32 v4, v4, 2, s3
    ds_add_rtn_u32 v196, v4, v11
.L47:
    s_mov_b64 exec, s[8:9]
    v_cmp_ne_u32 vcc, 0, v51
    s_and_saveexec_b64 s[8:9], vcc
    s_cbranch_execz .L48
    v_and_b32 v4, 0xff, v51
    v_lshl_add_u32 v4, v4, 2, s3
    ds_add_rtn_u32 v197, v4, v11
.L48:
    s_mov_b64 exec, s[8:9]
    v_cmp_ne_u32 vcc, 0, v53
    s_and_saveexec_b64 s[8:9], vcc
    s_cbranch_execz .L49
    v_and_b32 v4, 0xff, v53
    v_lshl_add_u32 v4, v4, 2, s3
    ds_add_rtn_u32 v198, v4, v11
.L49:
    s_mov_b64 exec, s[8:9]
    v_cmp_ne_u32 vcc, 0, v55
    s_and_saveexec_b64 s[8:9], vcc
    s_cbranch_execz .L50
    v_and_b32 v4, 0xff, v55
    v_lshl_add_u32 v4, v4, 2, s3
    ds_add_rtn_u32 v199, v4, v11
.L50:
    s_mov_b64 exec, s[8:9]
    v_cmp_ne_u32 vcc, 0, v57
    s_and_saveexec_b64 s[8:9], vcc
    s_cbranch_execz .L51
    v_and_b32 v4, 0xff, v57
    v_lshl_add_u32 v4, v4, 2, s3
    ds_add_rtn_u32 v200, v4, v11
.L51:
    s_mov_b64 exec, s[8:9]
    v_cmp_ne_u32 vcc, 0, v59
    s_and_saveexec_b64 s[8:9], vcc
    s_cbranch_execz .L52
    v_and_b32 v4, 0xff, v59
    v_lshl_add_u32 v4, v4, 2, s3
    ds_add_rtn_u32 v201, v4, v11
.L52:
    s_mov_b64 exec, s[8:9]
    v_cmp_ne_u32 vcc, 0, v61
    s_and_saveexec_b64 s[8:9], vcc
    s_cbranch_execz .L53
    v_and_b32 v4, 0xff, v61
    v_lshl_add_u32 v4, v4, 2, s3
    ds_add_rtn_u32 v202, v4, v11
.L53:
    s_mov_b64 exec, s[8:9]
    v_cmp_ne_u32 vcc, 0, v63
    s_and_saveexec_b64 s[8:9], vcc
    s_cbranch_execz .L54
    v_and_b32 v4, 0xff, v63
    v_lshl_add_u32 v4, v4, 2, s3
    ds_add_rtn_u32 v203, v4, v11
.L54:
    s_mov_b64 exec, s[8:9]
    v_cmp_ne_u32 vcc, 0, v65
    s_and_saveexec_b64 s[8:9], vcc
    s_cbranch_execz .L55
    v_and_b32 v4, 0xff, v65
    v_lshl_add_u32 v4, v4, 2, s3
    ds_add_rtn_u32 v204, v4, v11
.L55:
    s_mov_b64 exec, s[8:9]
    v_cmp_ne_u32 vcc, 0, v67
    s_and_saveexec_b64 s[8:9], vcc
    s_cbranch_execz .L56
    v_and_b32 v4, 0xff, v67
    v_lshl_add_u32 v4, v4, 2, s3
    ds_add_rtn_u32 v205, v4, v11
.L56:
    s_mov_b64 exec, s[8:9]
    v_cmp_ne_u32 vcc, 0, v69
    s_and_saveexec_b64 s[8:9], vcc
    s_cbranch_execz .L57
    v_and_b32 v4, 0xff, v69
    v_lshl_add_u32 v4, v4, 2, s3
    ds_add_rtn_u32 v206, v4, v11
.L57:
    s_mov_b64 exec, s[8:9]
    v_cmp_ne_u32 vcc, 0, v71
    s_and_saveexec_b64 s[8:9], vcc
    s_cbranch_execz .L58
    v_and_b32 v4, 0xff, v71
    v_lshl_add_u32 v4, v4, 2, s3
    ds_add_rtn_u32 v207, v4, v11
.L58:
    s_mov_b64 exec, s[8:9]
    v_cmp_ne_u32 vcc, 0, v73
    s_and_saveexec_b64 s[8:9], vcc
    s_cbranch_execz .L59
    v_and_b32 v4, 0xff, v73
    v_lshl_add_u32 v4, v4, 2, s3
    ds_add_rtn_u32 v208, v4, v11
.L59:
    s_mov_b64 exec, s[8:9]
    v_cmp_ne_u32 vcc, 0, v75
    s_and_saveexec_b64 s[8:9], vcc
    s_cbranch_execz .L60
    v_and_b32 v4, 0xff, v75
    v_lshl_add_u32 v4, v4, 2, s3
    ds_add_rtn_u32 v209, v4, v11
.L60:
    s_mov_b64 exec, s[8:9]
    v_cmp_ne_u32 vcc, 0, v77
    s_and_saveexec_b64 s[8:9], vcc
    s_cbranch_execz .L61
    v_and_b32 v4, 0xff, v77
    v_lshl_add_u32 v4, v4, 2, s3
    ds_add_rtn_u32 v210, v4, v11
.L61:
    s_mov_b64 exec, s[8:9]
    v_cmp_ne_u32 vcc, 0, v79
    s_and_saveexec_b64 s[8:9], vcc
    s_cbranch_execz .L62
    v_and_b32 v4, 0xff, v79
    v_lshl_add_u32 v4, v4, 2, s3
    ds_add_rtn_u32 v211, v4, v11
.L62:
    s_mov_b64 exec, s[8:9]
.L46:
    s_waitcnt lgkmcnt(0)
    s_waitcnt lgkmcnt(0)
    v_mov_b32 v10, 161644
    v_mov_b32 v11, 1
    s_mov_b64 s[8:9], exec
    s_mov_b64 exec, 1
    ds_add_u32 v10, v11
    s_mov_b64 exec, s[8:9]
    v_mov_b32 v10, 161644
    s_mov_b32 s3, 0x200000
.L63:
    ds_read_b32 v11, v10
    s_waitcnt lgkmcnt(0)
    v_readfirstlane_b32 s4, v11
    s_nop 3
    s_cmp_ge_u32 s4, 4
    s_cbranch_scc1 .L64
    s_sub_u32 s3, s3, 1
    s_cmp_lg_u32 s3, 0
    s_cbranch_scc1 .L63
.L64:
    v_mul_u32_u24 v7, 3, v1
    v_lshlrev_b32 v9, 2, v7
    v_add_u32 v9, 158980, v9
    v_mov_b32 v11, 161600
    ds_read_b32 v4, v9
    ds_read_b32 v5, v9 offset:4
    ds_read_b32 v6, v9 offset:8
    ds_read_b32 v11, v11
    s_waitcnt lgkmcnt(0)
    v_readfirstlane_b32 s90, v11
    v_add_u32 v4, 3, v4
    v_add_u32 v10, 0, v7
    v_lshrrev_b32 v4, 2, v4
    v_cmp_gt_u32 vcc, s81, v10
    v_max_u32 v4, 1, v4
    s_nop 0
    v_cndmask_b32 v4, 0, v4, vcc
    v_add_u32 v5, 3, v5
    v_add_u32 v10, 1, v7
    v_lshrrev_b32 v5, 2, v5
    v_cmp_gt_u32 vcc, s81, v10
    v_max_u32 v5, 1, v5
    s_nop 0
    v_cndmask_b32 v5, 0, v5, vcc
    v_add_u32 v6, 3, v6
    v_add_u32 v10, 2, v7
    v_lshrrev_b32 v6, 2, v6
    v_cmp_gt_u32 vcc, s81, v10
    v_max_u32 v6, 1, v6
    s_nop 0
    v_cndmask_b32 v6, 0, v6, vcc
    v_add3_u32 v8, v4, v5, v6
    v_mov_b32 v10, v8
    s_nop 1
    v_add_u32_dpp v10, v10, v10 row_shr:1 row_mask:0xf bank_mask:0xf bound_ctrl:0
    s_nop 1
    v_add_u32_dpp v10, v10, v10 row_shr:2 row_mask:0xf bank_mask:0xf bound_ctrl:0
    s_nop 1
    v_add_u32_dpp v10, v10, v10 row_shr:4 row_mask:0xf bank_mask:0xf bound_ctrl:0
    s_nop 1
    v_add_u32_dpp v10, v10, v10 row_shr:8 row_mask:0xf bank_mask:0xf bound_ctrl:0
    s_nop 1
    v_add_u32_dpp v10, v10, v10 row_bcast:15 row_mask:0xa bank_mask:0xf
    s_nop 1
    v_add_u32_dpp v10, v10, v10 row_bcast:31 row_mask:0xc bank_mask:0xf
    s_nop 1
    v_readlane_b32 s84, v10, 63
    v_sub_u32 v10, v10, v8
    v_cmp_gt_u32 vcc, 54, v1
    s_add_u32 s82, s84, 31
    s_lshr_b32 s82, s82, 5
    s_and_saveexec_b64 s[8:9], vcc
    v_lshlrev_b32 v9, 2, v7
    v_add_u32 v9, 152832, v9
    s_mov_b32 s3, 120064
    v_mov_b32 v8, 0x10000
    v_lshl_add_u32 v11, v10, 4, s3
    ds_write_b32 v9, v11 offset:6804
    v_cmp_ne_u32 vcc, 0, v4
    v_lshl_or_b32 v11, v4, 16, v10
    v_add_u32 v10, v10, v4
    v_cndmask_b32 v11, v8, v11, vcc
    ds_write_b32 v9, v11 offset:7456
    v_lshl_add_u32 v11, v10, 4, s3
    ds_write_b32 v9, v11 offset:6808
    v_cmp_ne_u32 vcc, 0, v5
    v_lshl_or_b32 v11, v5, 16, v10
    v_add_u32 v10, v10, v5
    v_cndmask_b32 v11, v8, v11, vcc
    ds_write_b32 v9, v11 offset:7460
    v_lshl_add_u32 v11, v10, 4, s3
    ds_write_b32 v9, v11 offset:6812
    v_cmp_ne_u32 vcc, 0, v6
    v_lshl_or_b32 v11, v6, 16, v10
    v_add_u32 v10, v10, v6
    v_cndmask_b32 v11, v8, v11, vcc
    ds_write_b32 v9, v11 offset:7464
    s_mov_b64 exec, s[8:9]
    v_mov_b32 v5, s84
    v_mov_b32 v6, 161604
    ds_write_b32 v6, v5
    v_cvt_f32_u32 v4, s82
    s_nop 0
    v_rcp_f32 v4, v4
    s_waitcnt lgkmcnt(0)
    v_readfirstlane_b32 s83, v4
    s_cmp_gt_u32 s84, 1024
    s_cbranch_scc1 .L65
    ds_read_b32 v128, v96 offset:656
    ds_read_b32 v129, v97 offset:656
    ds_read_b32 v130, v98 offset:656
    ds_read_b32 v131, v99 offset:656
    ds_read_b32 v132, v100 offset:656
    ds_read_b32 v133, v101 offset:656
    ds_read_b32 v134, v102 offset:656
    ds_read_b32 v135, v103 offset:656
    ds_read_b32 v136, v104 offset:656
    ds_read_b32 v137, v105 offset:656
    ds_read_b32 v138, v106 offset:656
    ds_read_b32 v139, v107 offset:656
    s_waitcnt lgkmcnt(4)
    ds_read_b32 v140, v108 offset:656
    ds_read_b32 v141, v109 offset:656
    ds_read_b32 v142, v110 offset:656
    ds_read_b32 v143, v111 offset:656
    s_waitcnt lgkmcnt(0)
    v_lshl_add_u32 v128, v80, 2, v128
    v_and_b32 v96, 0x3fff00, v48
    v_cmpx_ne_u32 vcc, 0, v48
    ds_write_b32 v128, v96
    ds_write_b32 v128, v112 offset:16384
    s_mov_b64 exec, -1
    v_lshl_add_u32 v129, v81, 2, v129
    v_and_b32 v97, 0x3fff00, v50
    v_cmpx_ne_u32 vcc, 0, v50
    ds_write_b32 v129, v97
    ds_write_b32 v129, v113 offset:16384
    s_mov_b64 exec, -1
    v_lshl_add_u32 v130, v82, 2, v130
    v_and_b32 v98, 0x3fff00, v52
    v_cmpx_ne_u32 vcc, 0, v52
    ds_write_b32 v130, v98
    ds_write_b32 v130, v114 offset:16384
    s_mov_b64 exec, -1
    v_lshl_add_u32 v131, v83, 2, v131
    v_and_b32 v99, 0x3fff00, v54
    v_cmpx_ne_u32 vcc, 0, v54
    ds_write_b32 v131, v99
    ds_write_b32 v131, v115 offset:16384
    s_mov_b64 exec, -1
    v_lshl_add_u32 v132, v84, 2, v132
    v_and_b32 v100, 0x3fff00, v56
    v_cmpx_ne_u32 vcc, 0, v56
    ds_write_b32 v132, v100
    ds_write_b32 v132, v116 offset:16384
    s_mov_b64 exec, -1
    v_lshl_add_u32 v133, v85, 2, v133
    v_and_b32 v101, 0x3fff00, v58
    v_cmpx_ne_u32 vcc, 0, v58
    ds_write_b32 v133, v101
    ds_write_b32 v133, v117 offset:16384
    s_mov_b64 exec, -1
    v_lshl_add_u32 v134, v86, 2, v134
    v_and_b32 v102, 0x3fff00, v60
    v_cmpx_ne_u32 vcc, 0, v60
    ds_write_b32 v134, v102
    ds_write_b32 v134, v118 offset:16384
    s_mov_b64 exec, -1
    v_lshl_add_u32 v135, v87, 2, v135
    v_and_b32 v103, 0x3fff00, v62
    v_cmpx_ne_u32 vcc, 0, v62
    ds_write_b32 v135, v103
    ds_write_b32 v135, v119 offset:16384
    s_mov_b64 exec, -1
    v_lshl_add_u32 v136, v88, 2, v136
    v_and_b32 v104, 0x3fff00, v64
    v_cmpx_ne_u32 vcc, 0, v64
    ds_write_b32 v136, v104
    ds_write_b32 v136, v120 offset:16384
    s_mov_b64 exec, -1
    v_lshl_add_u32 v137, v89, 2, v137
    v_and_b32 v105, 0x3fff00, v66
    v_cmpx_ne_u32 vcc, 0, v66
    ds_write_b32 v137, v105
    ds_write_b32 v137, v121 offset:16384
    s_mov_b64 exec, -1
    v_lshl_add_u32 v138, v90, 2, v138
    v_and_b32 v106, 0x3fff00, v68
    v_cmpx_ne_u32 vcc, 0, v68
    ds_write_b32 v138, v106
    ds_write_b32 v138, v122 offset:16384
    s_mov_b64 exec, -1
    v_lshl_add_u32 v139, v91, 2, v139
    v_and_b32 v107, 0x3fff00, v70
    v_cmpx_ne_u32 vcc, 0, v70
    ds_write_b32 v139, v107
    ds_write_b32 v139, v123 offset:16384
    s_mov_b64 exec, -1
    v_lshl_add_u32 v140, v92, 2, v140
    v_and_b32 v108, 0x3fff00, v72
    v_cmpx_ne_u32 vcc, 0, v72
    ds_write_b32 v140, v108
    ds_write_b32 v140, v124 offset:16384
    s_mov_b64 exec, -1
    v_lshl_add_u32 v141, v93, 2, v141
    v_and_b32 v109, 0x3fff00, v74
    v_cmpx_ne_u32 vcc, 0, v74
    ds_write_b32 v141, v109
    ds_write_b32 v141, v125 offset:16384
    s_mov_b64 exec, -1
    v_lshl_add_u32 v142, v94, 2, v142
    v_and_b32 v110, 0x3fff00, v76
    v_cmpx_ne_u32 vcc, 0, v76
    ds_write_b32 v142, v110
    ds_write_b32 v142, v126 offset:16384
    s_mov_b64 exec, -1
    v_lshl_add_u32 v143, v95, 2, v143
    v_and_b32 v111, 0x3fff00, v78
    v_cmpx_ne_u32 vcc, 0, v78
    ds_write_b32 v143, v111
    ds_write_b32 v143, v127 offset:16384
    s_mov_b64 exec, -1
    s_cmp_eq_u32 s85, 0
    s_cbranch_scc1 .L66
    s_mov_b32 s3, 158976
    v_cmp_ne_u32 vcc, 0, v49
    s_and_saveexec_b64 s[8:9], vcc
    s_cbranch_execz .L67
    v_and_b32 v4, 0xff, v49
    v_lshl_add_u32 v4, v4, 2, s3
    ds_read_b32 v4, v4 offset:656
    v_lshrrev_b32 v5, 22, v49
    v_add_u32 v5, v5, v212
    v_add_u32 v5, 0, v5
    v_and_b32 v6, 0x3fff00, v49
    s_waitcnt lgkmcnt(0)
    v_lshl_add_u32 v4, v196, 2, v4
    ds_write_b32 v4, v6
    ds_write_b32 v4, v5 offset:16384
.L67:
    s_mov_b64 exec, s[8:9]
    v_cmp_ne_u32 vcc, 0, v51
    s_and_saveexec_b64 s[8:9], vcc
    s_cbranch_execz .L68
    v_and_b32 v4, 0xff, v51
    v_lshl_add_u32 v4, v4, 2, s3
    ds_read_b32 v4, v4 offset:656
    v_lshrrev_b32 v5, 22, v51
    v_add_u32 v5, v5, v212
    v_add_u32 v5, 2560, v5
    v_and_b32 v6, 0x3fff00, v51
    s_waitcnt lgkmcnt(0)
    v_lshl_add_u32 v4, v197, 2, v4
    ds_write_b32 v4, v6
    ds_write_b32 v4, v5 offset:16384
.L68:
    s_mov_b64 exec, s[8:9]
    v_cmp_ne_u32 vcc, 0, v53
    s_and_saveexec_b64 s[8:9], vcc
    s_cbranch_execz .L69
    v_and_b32 v4, 0xff, v53
    v_lshl_add_u32 v4, v4, 2, s3
    ds_read_b32 v4, v4 offset:656
    v_lshrrev_b32 v5, 22, v53
    v_add_u32 v5, v5, v212
    v_add_u32 v5, 5120, v5
    v_and_b32 v6, 0x3fff00, v53
    s_waitcnt lgkmcnt(0)
    v_lshl_add_u32 v4, v198, 2, v4
    ds_write_b32 v4, v6
    ds_write_b32 v4, v5 offset:16384
.L69:
    s_mov_b64 exec, s[8:9]
    v_cmp_ne_u32 vcc, 0, v55
    s_and_saveexec_b64 s[8:9], vcc
    s_cbranch_execz .L70
    v_and_b32 v4, 0xff, v55
    v_lshl_add_u32 v4, v4, 2, s3
    ds_read_b32 v4, v4 offset:656
    v_lshrrev_b32 v5, 22, v55
    v_add_u32 v5, v5, v212
    v_add_u32 v5, 7680, v5
    v_and_b32 v6, 0x3fff00, v55
    s_waitcnt lgkmcnt(0)
    v_lshl_add_u32 v4, v199, 2, v4
    ds_write_b32 v4, v6
    ds_write_b32 v4, v5 offset:16384
.L70:
    s_mov_b64 exec, s[8:9]
    v_cmp_ne_u32 vcc, 0, v57
    s_and_saveexec_b64 s[8:9], vcc
    s_cbranch_execz .L71
    v_and_b32 v4, 0xff, v57
    v_lshl_add_u32 v4, v4, 2, s3
    ds_read_b32 v4, v4 offset:656
    v_lshrrev_b32 v5, 22, v57
    v_add_u32 v5, v5, v212
    v_add_u32 v5, 10240, v5
    v_and_b32 v6, 0x3fff00, v57
    s_waitcnt lgkmcnt(0)
    v_lshl_add_u32 v4, v200, 2, v4
    ds_write_b32 v4, v6
    ds_write_b32 v4, v5 offset:16384
.L71:
    s_mov_b64 exec, s[8:9]
    v_cmp_ne_u32 vcc, 0, v59
    s_and_saveexec_b64 s[8:9], vcc
    s_cbranch_execz .L72
    v_and_b32 v4, 0xff, v59
    v_lshl_add_u32 v4, v4, 2, s3
    ds_read_b32 v4, v4 offset:656
    v_lshrrev_b32 v5, 22, v59
    v_add_u32 v5, v5, v212
    v_add_u32 v5, 12800, v5
    v_and_b32 v6, 0x3fff00, v59
    s_waitcnt lgkmcnt(0)
    v_lshl_add_u32 v4, v201, 2, v4
    ds_write_b32 v4, v6
    ds_write_b32 v4, v5 offset:16384
.L72:
    s_mov_b64 exec, s[8:9]
    v_cmp_ne_u32 vcc, 0, v61
    s_and_saveexec_b64 s[8:9], vcc
    s_cbranch_execz .L73
    v_and_b32 v4, 0xff, v61
    v_lshl_add_u32 v4, v4, 2, s3
    ds_read_b32 v4, v4 offset:656
    v_lshrrev_b32 v5, 22, v61
    v_add_u32 v5, v5, v212
    v_add_u32 v5, 15360, v5
    v_and_b32 v6, 0x3fff00, v61
    s_waitcnt lgkmcnt(0)
    v_lshl_add_u32 v4, v202, 2, v4
    ds_write_b32 v4, v6
    ds_write_b32 v4, v5 offset:16384
.L73:
    s_mov_b64 exec, s[8:9]
    v_cmp_ne_u32 vcc, 0, v63
    s_and_saveexec_b64 s[8:9], vcc
    s_cbranch_execz .L74
    v_and_b32 v4, 0xff, v63
    v_lshl_add_u32 v4, v4, 2, s3
    ds_read_b32 v4, v4 offset:656
    v_lshrrev_b32 v5, 22, v63
    v_add_u32 v5, v5, v212
    v_add_u32 v5, 17920, v5
    v_and_b32 v6, 0x3fff00, v63
    s_waitcnt lgkmcnt(0)
    v_lshl_add_u32 v4, v203, 2, v4
    ds_write_b32 v4, v6
    ds_write_b32 v4, v5 offset:16384
.L74:
    s_mov_b64 exec, s[8:9]
    v_cmp_ne_u32 vcc, 0, v65
    s_and_saveexec_b64 s[8:9], vcc
    s_cbranch_execz .L75
    v_and_b32 v4, 0xff, v65
    v_lshl_add_u32 v4, v4, 2, s3
    ds_read_b32 v4, v4 offset:656
    v_lshrrev_b32 v5, 22, v65
    v_add_u32 v5, v5, v212
    v_add_u32 v5, 20480, v5
    v_and_b32 v6, 0x3fff00, v65
    s_waitcnt lgkmcnt(0)
    v_lshl_add_u32 v4, v204, 2, v4
    ds_write_b32 v4, v6
    ds_write_b32 v4, v5 offset:16384
.L75:
    s_mov_b64 exec, s[8:9]
    v_cmp_ne_u32 vcc, 0, v67
    s_and_saveexec_b64 s[8:9], vcc
    s_cbranch_execz .L76
    v_and_b32 v4, 0xff, v67
    v_lshl_add_u32 v4, v4, 2, s3
    ds_read_b32 v4, v4 offset:656
    v_lshrrev_b32 v5, 22, v67
    v_add_u32 v5, v5, v212
    v_add_u32 v5, 23040, v5
    v_and_b32 v6, 0x3fff00, v67
    s_waitcnt lgkmcnt(0)
    v_lshl_add_u32 v4, v205, 2, v4
    ds_write_b32 v4, v6
    ds_write_b32 v4, v5 offset:16384
.L76:
    s_mov_b64 exec, s[8:9]
    v_cmp_ne_u32 vcc, 0, v69
    s_and_saveexec_b64 s[8:9], vcc
    s_cbranch_execz .L77
    v_and_b32 v4, 0xff, v69
    v_lshl_add_u32 v4, v4, 2, s3
    ds_read_b32 v4, v4 offset:656
    v_lshrrev_b32 v5, 22, v69
    v_add_u32 v5, v5, v212
    v_add_u32 v5, 25600, v5
    v_and_b32 v6, 0x3fff00, v69
    s_waitcnt lgkmcnt(0)
    v_lshl_add_u32 v4, v206, 2, v4
    ds_write_b32 v4, v6
    ds_write_b32 v4, v5 offset:16384
.L77:
    s_mov_b64 exec, s[8:9]
    v_cmp_ne_u32 vcc, 0, v71
    s_and_saveexec_b64 s[8:9], vcc
    s_cbranch_execz .L78
    v_and_b32 v4, 0xff, v71
    v_lshl_add_u32 v4, v4, 2, s3
    ds_read_b32 v4, v4 offset:656
    v_lshrrev_b32 v5, 22, v71
    v_add_u32 v5, v5, v212
    v_add_u32 v5, 28160, v5
    v_and_b32 v6, 0x3fff00, v71
    s_waitcnt lgkmcnt(0)
    v_lshl_add_u32 v4, v207, 2, v4
    ds_write_b32 v4, v6
    ds_write_b32 v4, v5 offset:16384
.L78:
    s_mov_b64 exec, s[8:9]
    v_cmp_ne_u32 vcc, 0, v73
    s_and_saveexec_b64 s[8:9], vcc
    s_cbranch_execz .L79
    v_and_b32 v4, 0xff, v73
    v_lshl_add_u32 v4, v4, 2, s3
    ds_read_b32 v4, v4 offset:656
    v_lshrrev_b32 v5, 22, v73
    v_add_u32 v5, v5, v212
    v_add_u32 v5, 30720, v5
    v_and_b32 v6, 0x3fff00, v73
    s_waitcnt lgkmcnt(0)
    v_lshl_add_u32 v4, v208, 2, v4
    ds_write_b32 v4, v6
    ds_write_b32 v4, v5 offset:16384
.L79:
    s_mov_b64 exec, s[8:9]
    v_cmp_ne_u32 vcc, 0, v75
    s_and_saveexec_b64 s[8:9], vcc
    s_cbranch_execz .L80
    v_and_b32 v4, 0xff, v75
    v_lshl_add_u32 v4, v4, 2, s3
    ds_read_b32 v4, v4 offset:656
    v_lshrrev_b32 v5, 22, v75
    v_add_u32 v5, v5, v212
    v_add_u32 v5, 33280, v5
    v_and_b32 v6, 0x3fff00, v75
    s_waitcnt lgkmcnt(0)
    v_lshl_add_u32 v4, v209, 2, v4
    ds_write_b32 v4, v6
    ds_write_b32 v4, v5 offset:16384
.L80:
    s_mov_b64 exec, s[8:9]
    v_cmp_ne_u32 vcc, 0, v77
    s_and_saveexec_b64 s[8:9], vcc
    s_cbranch_execz .L81
    v_and_b32 v4, 0xff, v77
    v_lshl_add_u32 v4, v4, 2, s3
    ds_read_b32 v4, v4 offset:656
    v_lshrrev_b32 v5, 22, v77
    v_add_u32 v5, v5, v212
    v_add_u32 v5, 35840, v5
    v_and_b32 v6, 0x3fff00, v77
    s_waitcnt lgkmcnt(0)
    v_lshl_add_u32 v4, v210, 2, v4
    ds_write_b32 v4, v6
    ds_write_b32 v4, v5 offset:16384
.L81:
    s_mov_b64 exec, s[8:9]
    v_cmp_ne_u32 vcc, 0, v79
    s_and_saveexec_b64 s[8:9], vcc
    s_cbranch_execz .L82
    v_and_b32 v4, 0xff, v79
    v_lshl_add_u32 v4, v4, 2, s3
    ds_read_b32 v4, v4 offset:656
    v_lshrrev_b32 v5, 22, v79
    v_add_u32 v5, v5, v212
    v_add_u32 v5, 38400, v5
    v_and_b32 v6, 0x3fff00, v79
    s_waitcnt lgkmcnt(0)
    v_lshl_add_u32 v4, v211, 2, v4
    ds_write_b32 v4, v6
    ds_write_b32 v4, v5 offset:16384
.L82:
    s_mov_b64 exec, s[8:9]
.L66:
    s_mov_b32 s85, 0
    s_waitcnt lgkmcnt(0)
.L65:
    s_mov_b32 s85, 0
    v_mov_b32 v10, 161624
    s_mov_b32 s3, 0x200000
.L83:
    ds_read_b32 v11, v10
    s_waitcnt lgkmcnt(0)
    v_readfirstlane_b32 s4, v11
    s_nop 3
    s_cmp_ge_u32 s4, 4
    s_cbranch_scc1 .L84
    s_sleep 1
    s_sub_u32 s3, s3, 1
    s_cmp_lg_u32 s3, 0
    s_cbranch_scc1 .L83
.L84:
    s_lshl_b32 s4, s79, 2
    v_add_u32 v4, s4, v2
    v_mul_u32_u24 v5, 136, v3
    v_lshl_add_u32 v5, v4, 3, v5
    v_add_u32 v5, 81920, v5
    ds_read_b64 v[64:65], v5 offset:0
    ds_read_b64 v[66:67], v5 offset:2176
    ds_read_b64 v[68:69], v5 offset:4352
    ds_read_b64 v[70:71], v5 offset:6528
    ds_read_b64 v[72:73], v5 offset:8704
    s_waitcnt lgkmcnt(0)
    v_lshlrev_b32 v16, 16, v64
    v_lshlrev_b32 v17, 16, v65
    v_and_b32 v18, 0xffff0000, v64
    v_and_b32 v19, 0xffff0000, v65
    v_lshlrev_b32 v20, 16, v66
    v_lshlrev_b32 v21, 16, v67
    v_and_b32 v22, 0xffff0000, v66
    v_and_b32 v23, 0xffff0000, v67
    v_lshlrev_b32 v24, 16, v68
    v_lshlrev_b32 v25, 16, v69
    v_and_b32 v26, 0xffff0000, v68
    v_and_b32 v27, 0xffff0000, v69
    v_lshlrev_b32 v28, 16, v70
    v_lshlrev_b32 v29, 16, v71
    v_and_b32 v30, 0xffff0000, v70
    v_and_b32 v31, 0xffff0000, v71
    v_lshlrev_b32 v32, 16, v72
    v_lshlrev_b32 v33, 16, v73
    v_and_b32 v34, 0xffff0000, v72
    v_and_b32 v35, 0xffff0000, v73
.Ljoin8:
    s_cmp_lg_u32 s90, 0
    s_cbranch_scc1 .Lslow85_sw
    s_cmp_le_u32 s84, 1024
    s_cbranch_scc1 .Lrun86
.Lslow85_sw:
    s_mov_b32 s87, 1
    s_mov_b32 s85, 0
    s_branch .Lslow85
.Lrun86:
    v_lshrrev_b32 v4, 2, v1
    v_mov_b32 v5, 0x3f80
    v_mov_b32 v6, 0x3f800000
    v_cmp_eq_u32 vcc, 0, v4
    v_cmp_eq_u32 s[8:9], 1, v4
    s_nop 1
    v_cndmask_b32 v7, 0, v5, vcc
    v_cndmask_b32 v7, v7, v6, s[8:9]
    v_mov_b32 v130, v7
    v_mov_b32 v134, v7
    v_cmp_eq_u32 vcc, 2, v4
    v_cmp_eq_u32 s[8:9], 3, v4
    s_nop 1
    v_cndmask_b32 v7, 0, v5, vcc
    v_cndmask_b32 v7, v7, v6, s[8:9]
    v_mov_b32 v131, v7
    v_mov_b32 v135, v7
    s_lshl_b32 s3, s78, 2
    v_add_u32 v4, s3, v2
    v_mul_lo_u32 v4, v4, s82
    v_lshlrev_b32 v226, 4, v4
    v_add_u32 v226, 120064, v226
    v_lshlrev_b32 v229, 1, v4
    v_add_u32 v229, 154880, v229
    v_bfe_u32 v5, v1, 2, 2
    v_add_u32 v5, s3, v5
    v_mul_lo_u32 v5, v5, s82
    v_lshlrev_b32 v227, 4, v5
    v_lshl_add_u32 v227, v14, 2, v227
    v_add_u32 v227, 136448, v227
    v_lshlrev_b32 v228, 1, v5
    v_add_u32 v228, 152832, v228
    v_mov_b32 v224, 0
    v_mov_b32 v204, 0
    v_mov_b32 v208, 0
    v_mov_b32 v205, 0
    v_mov_b32 v209, 0
    v_mov_b32 v206, 0
    v_mov_b32 v210, 0
    v_mov_b32 v207, 0
    v_mov_b32 v211, 0
    s_cmp_lg_u32 s78, 0
    s_cbranch_scc1 .L88
    s_lshl_b32 s4, s77, 3
    s_add_u32 s4, s4, 32
    v_add_u32 v4, s4, v1
    v_readfirstlane_b32 s3, v47
    s_mov_b32 s5, 0x400000
.L91:
    s_cmp_lg_u32 s3, 0
    s_cbranch_scc1 .L92
    v_mov_b32 v47, 0
    global_load_dword v47, v47, s[36:37] sc1
    s_waitcnt vmcnt(0)
    v_readfirstlane_b32 s3, v47
    s_sub_u32 s5, s5, 1
    s_cmp_lg_u32 s5, 0
    s_cbranch_scc1 .L91
.L92:
    v_lshlrev_b32 v4, 7, v4
    v_cmp_gt_u32 vcc, 8, v1
    s_and_saveexec_b64 s[8:9], vcc
    s_mov_b32 s3, 0x40000
.L89:
    global_load_dword v5, v4, s[56:57] sc1
    s_waitcnt vmcnt(0)
    v_cmp_gt_u32 vcc, 8, v5
    s_nop 1
    s_cmp_eq_u64 vcc, 0
    s_cbranch_scc1 .L90
    s_sleep 1
    s_sub_u32 s3, s3, 1
    s_cmp_lg_u32 s3, 0
    s_cbranch_scc1 .L89
.L90:
    s_mov_b64 exec, s[8:9]
.L88:
    s_waitcnt lgkmcnt(0)
    s_barrier
    ds_read_b128 v[164:167], v226 offset:0
    ds_read_b32 v184, v227 offset:0
    ds_read_b128 v[168:171], v226 offset:16
    ds_read_b32 v185, v227 offset:16
    ds_read_u16 v221, v228
    s_waitcnt lgkmcnt(0)
    s_cmp_gt_u32 s82, 0
    s_cselect_b32 s96, 0, s97
    v_add_u32 v164, v164, v12
    v_add_u32 v165, v165, v12
    v_add_u32 v166, v166, v12
    v_add_u32 v167, v167, v12
    v_lshl_add_u32 v230, v184, 5, v13
    buffer_load_dwordx2 v[128:129], v230, s[44:47], s96 offen
    buffer_load_dwordx4 v[48:51], v164, s[48:51], s96 offen sc1
    buffer_load_dwordx4 v[52:55], v165, s[48:51], s96 offen sc1
    buffer_load_dwordx4 v[56:59], v166, s[48:51], s96 offen sc1
    buffer_load_dwordx4 v[60:63], v167, s[48:51], s96 offen sc1
    s_cmp_gt_u32 s82, 1
    s_cselect_b32 s96, 0, s97
    v_add_u32 v168, v168, v12
    v_add_u32 v169, v169, v12
    v_add_u32 v170, v170, v12
    v_add_u32 v171, v171, v12
    v_lshl_add_u32 v230, v185, 5, v13
    buffer_load_dwordx2 v[132:133], v230, s[44:47], s96 offen
    buffer_load_dwordx4 v[64:67], v168, s[48:51], s96 offen sc1
    buffer_load_dwordx4 v[68:71], v169, s[48:51], s96 offen sc1
    buffer_load_dwordx4 v[72:75], v170, s[48:51], s96 offen sc1
    buffer_load_dwordx4 v[76:79], v171, s[48:51], s96 offen sc1
    v_add_lshl_u32 v223, v221, v14, 3
    ds_read_b64_tr_b16 v[150:151], v223 offset:0
    ds_read_b64_tr_b16 v[154:155], v223 offset:32
    ds_read_b64_tr_b16 v[158:159], v223 offset:64
    ds_read_b64_tr_b16 v[162:163], v223 offset:96
    ds_read_u16 v221, v228 offset:2
    s_waitcnt lgkmcnt(0)
    s_mov_b32 s93, s82
    s_mov_b32 s14, 0x11111111
    s_cmp_eq_u32 s80, 1
    s_cselect_b32 s14, 0xeeeeeeee, s14
.Lmain93:
    s_bitcmp1_b32 s14, s93
    s_cbranch_scc1 .L95
    s_setprio 0
    s_branch .L96
.L95:
    s_setprio 1
.L96:
    s_waitcnt vmcnt(5) lgkmcnt(2)
    v_mfma_f32_16x16x32_bf16 v[164:167], v[128:131], v[148:151], 0
    v_mfma_f32_16x16x32_bf16 v[168:171], v[128:131], v[152:155], 0
    v_mfma_f32_16x16x32_bf16 v[172:175], v[128:131], v[156:159], 0
    v_mfma_f32_16x16x32_bf16 v[176:179], v[128:131], v[160:163], 0
    s_cmp_gt_u32 s93, 2
    s_cselect_b32 s96, 0, s97
    v_add_lshl_u32 v223, v221, v14, 3
    ds_read_b64_tr_b16 v[150:151], v223 offset:0
    ds_read_b64_tr_b16 v[154:155], v223 offset:32
    ds_read_b64_tr_b16 v[158:159], v223 offset:64
    ds_read_b64_tr_b16 v[162:163], v223 offset:96
    ds_read_u16 v222, v229 offset:0
    ds_read_u16_d16_hi v224, v229 offset:2048
    ds_read_u16 v221, v228 offset:4
    ds_read_b128 v[216:219], v226 offset:32
    ds_read_b32 v220, v227 offset:32
    v_lshlrev_b32 v196, 16, v50
    v_lshlrev_b32 v197, 16, v51
    v_lshlrev_b32 v198, 16, v54
    v_lshlrev_b32 v199, 16, v55
    v_lshlrev_b32 v200, 16, v58
    v_lshlrev_b32 v201, 16, v59
    v_lshlrev_b32 v202, 16, v62
    v_lshlrev_b32 v203, 16, v63
    v_dot2_f32_bf16 v180, v48, s91, v164
    v_dot2_f32_bf16 v181, v49, s91, v172
    v_dot2_f32_bf16 v182, v48, s92, v168
    v_dot2_f32_bf16 v183, v49, s92, v176
    v_dot2_f32_bf16 v184, v52, s91, v165
    v_dot2_f32_bf16 v185, v53, s91, v173
    v_dot2_f32_bf16 v186, v52, s92, v169
    v_dot2_f32_bf16 v187, v53, s92, v177
    v_dot2_f32_bf16 v188, v56, s91, v166
    v_dot2_f32_bf16 v189, v57, s91, v174
    v_dot2_f32_bf16 v190, v56, s92, v170
    v_dot2_f32_bf16 v191, v57, s92, v178
    v_dot2_f32_bf16 v192, v60, s91, v167
    v_dot2_f32_bf16 v193, v61, s91, v175
    v_dot2_f32_bf16 v194, v60, s92, v171
    v_dot2_f32_bf16 v195, v61, s92, v179
    v_exp_f32 v180, v180
    v_exp_f32 v181, v181
    v_exp_f32 v182, v182
    v_exp_f32 v183, v183
    v_exp_f32 v184, v184
    v_exp_f32 v185, v185
    v_exp_f32 v186, v186
    v_exp_f32 v187, v187
    v_exp_f32 v188, v188
    v_exp_f32 v189, v189
    v_exp_f32 v190, v190
    v_exp_f32 v191, v191
    v_exp_f32 v192, v192
    v_exp_f32 v193, v193
    v_exp_f32 v194, v194
    v_exp_f32 v195, v195
    v_pk_add_f32 v[180:181], v[180:181], s[94:95]
    v_pk_add_f32 v[182:183], v[182:183], s[94:95]
    v_pk_add_f32 v[184:185], v[184:185], s[94:95]
    v_pk_add_f32 v[186:187], v[186:187], s[94:95]
    v_pk_add_f32 v[188:189], v[188:189], s[94:95]
    v_pk_add_f32 v[190:191], v[190:191], s[94:95]
    v_pk_add_f32 v[192:193], v[192:193], s[94:95]
    v_pk_add_f32 v[194:195], v[194:195], s[94:95]
    v_rcp_f32 v180, v180
    v_rcp_f32 v181, v181
    v_rcp_f32 v182, v182
    v_rcp_f32 v183, v183
    v_rcp_f32 v184, v184
    v_rcp_f32 v185, v185
    v_rcp_f32 v186, v186
    v_rcp_f32 v187, v187
    v_rcp_f32 v188, v188
    v_rcp_f32 v189, v189
    v_rcp_f32 v190, v190
    v_rcp_f32 v191, v191
    v_rcp_f32 v192, v192
    v_rcp_f32 v193, v193
    v_rcp_f32 v194, v194
    v_rcp_f32 v195, v195
    s_waitcnt lgkmcnt(0)
    v_lshl_add_u32 v231, v222, 5, v12
    v_pk_fma_f32 v[204:205], v[204:205], v[224:225], v[180:181] op_sel:[0,0,0] op_sel_hi:[1,0,1]
    v_pk_fma_f32 v[206:207], v[206:207], v[224:225], v[182:183] op_sel:[0,0,0] op_sel_hi:[1,0,1]
    v_pk_mul_f32 v[212:213], v[180:181], v[196:197]
    v_pk_mul_f32 v[214:215], v[182:183], v[50:51]
    v_pk_add_f32 v[204:205], v[204:205], v[184:185]
    v_pk_add_f32 v[206:207], v[206:207], v[186:187]
    v_pk_fma_f32 v[212:213], v[184:185], v[198:199], v[212:213]
    v_pk_fma_f32 v[214:215], v[186:187], v[54:55], v[214:215]
    v_pk_add_f32 v[204:205], v[204:205], v[188:189]
    v_pk_add_f32 v[206:207], v[206:207], v[190:191]
    v_pk_fma_f32 v[212:213], v[188:189], v[200:201], v[212:213]
    v_pk_fma_f32 v[214:215], v[190:191], v[58:59], v[214:215]
    v_pk_add_f32 v[204:205], v[204:205], v[192:193]
    v_pk_add_f32 v[206:207], v[206:207], v[194:195]
    v_pk_fma_f32 v[212:213], v[192:193], v[202:203], v[212:213]
    v_pk_fma_f32 v[214:215], v[194:195], v[62:63], v[214:215]
    v_add_u32 v216, v216, v12
    v_add_u32 v217, v217, v12
    v_add_u32 v218, v218, v12
    v_add_u32 v219, v219, v12
    v_lshl_add_u32 v230, v220, 5, v13
    buffer_load_dwordx2 v[128:129], v230, s[44:47], s96 offen
    buffer_load_dwordx4 v[48:51], v216, s[48:51], s96 offen sc1
    buffer_load_dwordx4 v[52:55], v217, s[48:51], s96 offen sc1
    buffer_load_dwordx4 v[56:59], v218, s[48:51], s96 offen sc1
    buffer_load_dwordx4 v[60:63], v219, s[48:51], s96 offen sc1
    v_pk_fma_f32 v[208:209], v[208:209], v[224:225], v[212:213] op_sel:[0,0,0] op_sel_hi:[1,0,1]
    v_pk_fma_f32 v[210:211], v[210:211], v[224:225], v[214:215] op_sel:[0,0,0] op_sel_hi:[1,0,1]
    ds_write_b128 v231, v[204:207]
    ds_write_b128 v231, v[208:211] offset:256
    s_sub_u32 s93, s93, 1
    s_cmp_eq_u32 s93, 0
    s_cbranch_scc1 .Lmdone94
    s_bitcmp1_b32 s14, s93
    s_cbranch_scc1 .L97
    s_setprio 0
    s_branch .L98
.L97:
    s_setprio 1
.L98:
    s_waitcnt vmcnt(5) lgkmcnt(2)
    v_mfma_f32_16x16x32_bf16 v[164:167], v[132:135], v[148:151], 0
    v_mfma_f32_16x16x32_bf16 v[168:171], v[132:135], v[152:155], 0
    v_mfma_f32_16x16x32_bf16 v[172:175], v[132:135], v[156:159], 0
    v_mfma_f32_16x16x32_bf16 v[176:179], v[132:135], v[160:163], 0
    s_cmp_gt_u32 s93, 2
    s_cselect_b32 s96, 0, s97
    v_add_lshl_u32 v223, v221, v14, 3
    ds_read_b64_tr_b16 v[150:151], v223 offset:0
    ds_read_b64_tr_b16 v[154:155], v223 offset:32
    ds_read_b64_tr_b16 v[158:159], v223 offset:64
    ds_read_b64_tr_b16 v[162:163], v223 offset:96
    ds_read_u16 v222, v229 offset:2
    ds_read_u16_d16_hi v224, v229 offset:2050
    ds_read_u16 v221, v228 offset:6
    ds_read_b128 v[216:219], v226 offset:48
    ds_read_b32 v220, v227 offset:48
    v_lshlrev_b32 v196, 16, v66
    v_lshlrev_b32 v197, 16, v67
    v_lshlrev_b32 v198, 16, v70
    v_lshlrev_b32 v199, 16, v71
    v_lshlrev_b32 v200, 16, v74
    v_lshlrev_b32 v201, 16, v75
    v_lshlrev_b32 v202, 16, v78
    v_lshlrev_b32 v203, 16, v79
    v_dot2_f32_bf16 v180, v64, s91, v164
    v_dot2_f32_bf16 v181, v65, s91, v172
    v_dot2_f32_bf16 v182, v64, s92, v168
    v_dot2_f32_bf16 v183, v65, s92, v176
    v_dot2_f32_bf16 v184, v68, s91, v165
    v_dot2_f32_bf16 v185, v69, s91, v173
    v_dot2_f32_bf16 v186, v68, s92, v169
    v_dot2_f32_bf16 v187, v69, s92, v177
    v_dot2_f32_bf16 v188, v72, s91, v166
    v_dot2_f32_bf16 v189, v73, s91, v174
    v_dot2_f32_bf16 v190, v72, s92, v170
    v_dot2_f32_bf16 v191, v73, s92, v178
    v_dot2_f32_bf16 v192, v76, s91, v167
    v_dot2_f32_bf16 v193, v77, s91, v175
    v_dot2_f32_bf16 v194, v76, s92, v171
    v_dot2_f32_bf16 v195, v77, s92, v179
    v_exp_f32 v180, v180
    v_exp_f32 v181, v181
    v_exp_f32 v182, v182
    v_exp_f32 v183, v183
    v_exp_f32 v184, v184
    v_exp_f32 v185, v185
    v_exp_f32 v186, v186
    v_exp_f32 v187, v187
    v_exp_f32 v188, v188
    v_exp_f32 v189, v189
    v_exp_f32 v190, v190
    v_exp_f32 v191, v191
    v_exp_f32 v192, v192
    v_exp_f32 v193, v193
    v_exp_f32 v194, v194
    v_exp_f32 v195, v195
    v_pk_add_f32 v[180:181], v[180:181], s[94:95]
    v_pk_add_f32 v[182:183], v[182:183], s[94:95]
    v_pk_add_f32 v[184:185], v[184:185], s[94:95]
    v_pk_add_f32 v[186:187], v[186:187], s[94:95]
    v_pk_add_f32 v[188:189], v[188:189], s[94:95]
    v_pk_add_f32 v[190:191], v[190:191], s[94:95]
    v_pk_add_f32 v[192:193], v[192:193], s[94:95]
    v_pk_add_f32 v[194:195], v[194:195], s[94:95]
    v_rcp_f32 v180, v180
    v_rcp_f32 v181, v181
    v_rcp_f32 v182, v182
    v_rcp_f32 v183, v183
    v_rcp_f32 v184, v184
    v_rcp_f32 v185, v185
    v_rcp_f32 v186, v186
    v_rcp_f32 v187, v187
    v_rcp_f32 v188, v188
    v_rcp_f32 v189, v189
    v_rcp_f32 v190, v190
    v_rcp_f32 v191, v191
    v_rcp_f32 v192, v192
    v_rcp_f32 v193, v193
    v_rcp_f32 v194, v194
    v_rcp_f32 v195, v195
    s_waitcnt lgkmcnt(0)
    v_lshl_add_u32 v231, v222, 5, v12
    v_pk_fma_f32 v[204:205], v[204:205], v[224:225], v[180:181] op_sel:[0,0,0] op_sel_hi:[1,0,1]
    v_pk_fma_f32 v[206:207], v[206:207], v[224:225], v[182:183] op_sel:[0,0,0] op_sel_hi:[1,0,1]
    v_pk_mul_f32 v[212:213], v[180:181], v[196:197]
    v_pk_mul_f32 v[214:215], v[182:183], v[66:67]
    v_pk_add_f32 v[204:205], v[204:205], v[184:185]
    v_pk_add_f32 v[206:207], v[206:207], v[186:187]
    v_pk_fma_f32 v[212:213], v[184:185], v[198:199], v[212:213]
    v_pk_fma_f32 v[214:215], v[186:187], v[70:71], v[214:215]
    v_pk_add_f32 v[204:205], v[204:205], v[188:189]
    v_pk_add_f32 v[206:207], v[206:207], v[190:191]
    v_pk_fma_f32 v[212:213], v[188:189], v[200:201], v[212:213]
    v_pk_fma_f32 v[214:215], v[190:191], v[74:75], v[214:215]
    v_pk_add_f32 v[204:205], v[204:205], v[192:193]
    v_pk_add_f32 v[206:207], v[206:207], v[194:195]
    v_pk_fma_f32 v[212:213], v[192:193], v[202:203], v[212:213]
    v_pk_fma_f32 v[214:215], v[194:195], v[78:79], v[214:215]
    v_add_u32 v216, v216, v12
    v_add_u32 v217, v217, v12
    v_add_u32 v218, v218, v12
    v_add_u32 v219, v219, v12
    v_lshl_add_u32 v230, v220, 5, v13
    buffer_load_dwordx2 v[132:133], v230, s[44:47], s96 offen
    buffer_load_dwordx4 v[64:67], v216, s[48:51], s96 offen sc1
    buffer_load_dwordx4 v[68:71], v217, s[48:51], s96 offen sc1
    buffer_load_dwordx4 v[72:75], v218, s[48:51], s96 offen sc1
    buffer_load_dwordx4 v[76:79], v219, s[48:51], s96 offen sc1
    v_pk_fma_f32 v[208:209], v[208:209], v[224:225], v[212:213] op_sel:[0,0,0] op_sel_hi:[1,0,1]
    v_pk_fma_f32 v[210:211], v[210:211], v[224:225], v[214:215] op_sel:[0,0,0] op_sel_hi:[1,0,1]
    ds_write_b128 v231, v[204:207]
    ds_write_b128 v231, v[208:211] offset:256
    v_add_u32 v226, 32, v226
    v_add_u32 v227, 32, v227
    v_add_u32 v228, 4, v228
    v_add_u32 v229, 4, v229
    s_sub_u32 s93, s93, 1
    s_cmp_eq_u32 s93, 0
    s_cbranch_scc0 .Lmain93
.Lmdone94:
    s_setprio 0
    s_waitcnt vmcnt(0) lgkmcnt(0)
    s_barrier
    s_cmp_eq_u32 s80, 0
    s_cbranch_scc1 .L99
    s_setprio 1
.L99:
    s_lshl_b32 s3, s79, 2
    v_add_u32 v138, s3, v2
    v_lshlrev_b32 v138, 4, v138
    s_mov_b32 s4, 152832
    v_lshl_add_u32 v139, v15, 2, s4
    v_lshl_add_u32 v140, v15, 9, v138
    ds_read_b32 v128, v139 offset:8128
    ds_read_b32 v129, v139 offset:8192
    ds_read_b32 v130, v139 offset:8256
    ds_read_b32 v131, v139 offset:8320
    ds_read_b32 v132, v139 offset:8384
    ds_read_b128 v[48:51], v140 offset:0
    ds_read_b128 v[52:55], v140 offset:256
    ds_read_b128 v[56:59], v140 offset:8192
    ds_read_b128 v[60:63], v140 offset:8448
    ds_read_b128 v[64:67], v140 offset:16384
    ds_read_b128 v[68:71], v140 offset:16640
    ds_read_b128 v[72:75], v140 offset:24576
    ds_read_b128 v[76:79], v140 offset:24832
    ds_read_b128 v[80:83], v140 offset:32768
    ds_read_b128 v[84:87], v140 offset:33024
    s_waitcnt lgkmcnt(10)
    v_mov_b32 v139, 262144
    s_mov_b32 s4, 81920
    v_add_u32 v140, s4, v138
    v_cmp_lt_u32 vcc, 0xff, v128
    v_and_b32 v133, 0xff, v128
    v_lshl_add_u32 v133, v133, 9, v140
    v_cndmask_b32 v133, v139, v133, vcc
    v_cmp_lt_u32 vcc, 0xff, v129
    v_and_b32 v134, 0xff, v129
    v_lshl_add_u32 v134, v134, 9, v140
    v_cndmask_b32 v134, v139, v134, vcc
    v_cmp_lt_u32 vcc, 0xff, v130
    v_and_b32 v135, 0xff, v130
    v_lshl_add_u32 v135, v135, 9, v140
    v_cndmask_b32 v135, v139, v135, vcc
    v_cmp_lt_u32 vcc, 0xff, v131
    v_and_b32 v136, 0xff, v131
    v_lshl_add_u32 v136, v136, 9, v140
    v_cndmask_b32 v136, v139, v136, vcc
    v_cmp_lt_u32 vcc, 0xff, v132
    v_and_b32 v137, 0xff, v132
    v_lshl_add_u32 v137, v137, 9, v140
    v_cndmask_b32 v137, v139, v137, vcc
    s_waitcnt lgkmcnt(0)
    ds_read_b128 v[88:91], v133
    ds_read_b128 v[92:95], v133 offset:256
    ds_read_b128 v[96:99], v134
    ds_read_b128 v[100:103], v134 offset:256
    ds_read_b128 v[104:107], v135
    ds_read_b128 v[108:111], v135 offset:256
    ds_read_b128 v[112:115], v136
    ds_read_b128 v[116:119], v136 offset:256
    ds_read_b128 v[120:123], v137
    ds_read_b128 v[124:127], v137 offset:256
    v_lshrrev_b32 v139, 8, v128
    v_lshrrev_b32 v141, 8, v129
    v_max_u32 v139, v139, v141
    v_lshrrev_b32 v141, 8, v130
    v_max_u32 v139, v139, v141
    v_lshrrev_b32 v141, 8, v131
    v_max_u32 v139, v139, v141
    v_lshrrev_b32 v141, 8, v132
    v_max_u32 v139, v139, v141
    v_cmp_lt_u32 vcc, 1, v139
    s_waitcnt lgkmcnt(0)
    v_pk_add_f32 v[48:49], v[48:49], v[88:89]
    v_pk_add_f32 v[50:51], v[50:51], v[90:91]
    v_pk_add_f32 v[52:53], v[52:53], v[92:93]
    v_pk_add_f32 v[54:55], v[54:55], v[94:95]
    v_pk_add_f32 v[56:57], v[56:57], v[96:97]
    v_pk_add_f32 v[58:59], v[58:59], v[98:99]
    v_pk_add_f32 v[60:61], v[60:61], v[100:101]
    v_pk_add_f32 v[62:63], v[62:63], v[102:103]
    v_pk_add_f32 v[64:65], v[64:65], v[104:105]
    v_pk_add_f32 v[66:67], v[66:67], v[106:107]
    v_pk_add_f32 v[68:69], v[68:69], v[108:109]
    v_pk_add_f32 v[70:71], v[70:71], v[110:111]
    v_pk_add_f32 v[72:73], v[72:73], v[112:113]
    v_pk_add_f32 v[74:75], v[74:75], v[114:115]
    v_pk_add_f32 v[76:77], v[76:77], v[116:117]
    v_pk_add_f32 v[78:79], v[78:79], v[118:119]
    v_pk_add_f32 v[80:81], v[80:81], v[120:121]
    v_pk_add_f32 v[82:83], v[82:83], v[122:123]
    v_pk_add_f32 v[84:85], v[84:85], v[124:125]
    v_pk_add_f32 v[86:87], v[86:87], v[126:127]
    s_cmp_eq_u64 vcc, 0
    s_cbranch_scc1 .L100
    v_lshrrev_b32 v139, 8, v128
    s_mov_b64 s[10:11], exec
.L101:
    v_cmp_lt_u32 vcc, 1, v139
    s_and_b64 exec, exec, vcc
    s_cbranch_execz .L102
    v_add_u32 v139, -1, v139
    v_add_u32 v133, 512, v133
    ds_read_b128 v[88:91], v133
    ds_read_b128 v[92:95], v133 offset:256
    s_waitcnt lgkmcnt(0)
    v_add_f32 v48, v48, v88
    v_add_f32 v49, v49, v89
    v_add_f32 v50, v50, v90
    v_add_f32 v51, v51, v91
    v_add_f32 v52, v52, v92
    v_add_f32 v53, v53, v93
    v_add_f32 v54, v54, v94
    v_add_f32 v55, v55, v95
    s_branch .L101
.L102:
    s_mov_b64 exec, s[10:11]
    v_lshrrev_b32 v139, 8, v129
    s_mov_b64 s[10:11], exec
.L103:
    v_cmp_lt_u32 vcc, 1, v139
    s_and_b64 exec, exec, vcc
    s_cbranch_execz .L104
    v_add_u32 v139, -1, v139
    v_add_u32 v134, 512, v134
    ds_read_b128 v[88:91], v134
    ds_read_b128 v[92:95], v134 offset:256
    s_waitcnt lgkmcnt(0)
    v_add_f32 v56, v56, v88
    v_add_f32 v57, v57, v89
    v_add_f32 v58, v58, v90
    v_add_f32 v59, v59, v91
    v_add_f32 v60, v60, v92
    v_add_f32 v61, v61, v93
    v_add_f32 v62, v62, v94
    v_add_f32 v63, v63, v95
    s_branch .L103
.L104:
    s_mov_b64 exec, s[10:11]
    v_lshrrev_b32 v139, 8, v130
    s_mov_b64 s[10:11], exec
.L105:
    v_cmp_lt_u32 vcc, 1, v139
    s_and_b64 exec, exec, vcc
    s_cbranch_execz .L106
    v_add_u32 v139, -1, v139
    v_add_u32 v135, 512, v135
    ds_read_b128 v[88:91], v135
    ds_read_b128 v[92:95], v135 offset:256
    s_waitcnt lgkmcnt(0)
    v_add_f32 v64, v64, v88
    v_add_f32 v65, v65, v89
    v_add_f32 v66, v66, v90
    v_add_f32 v67, v67, v91
    v_add_f32 v68, v68, v92
    v_add_f32 v69, v69, v93
    v_add_f32 v70, v70, v94
    v_add_f32 v71, v71, v95
    s_branch .L105
.L106:
    s_mov_b64 exec, s[10:11]
    v_lshrrev_b32 v139, 8, v131
    s_mov_b64 s[10:11], exec
.L107:
    v_cmp_lt_u32 vcc, 1, v139
    s_and_b64 exec, exec, vcc
    s_cbranch_execz .L108
    v_add_u32 v139, -1, v139
    v_add_u32 v136, 512, v136
    ds_read_b128 v[88:91], v136
    ds_read_b128 v[92:95], v136 offset:256
    s_waitcnt lgkmcnt(0)
    v_add_f32 v72, v72, v88
    v_add_f32 v73, v73, v89
    v_add_f32 v74, v74, v90
    v_add_f32 v75, v75, v91
    v_add_f32 v76, v76, v92
    v_add_f32 v77, v77, v93
    v_add_f32 v78, v78, v94
    v_add_f32 v79, v79, v95
    s_branch .L107
.L108:
    s_mov_b64 exec, s[10:11]
    v_lshrrev_b32 v139, 8, v132
    s_mov_b64 s[10:11], exec
.L109:
    v_cmp_lt_u32 vcc, 1, v139
    s_and_b64 exec, exec, vcc
    s_cbranch_execz .L110
    v_add_u32 v139, -1, v139
    v_add_u32 v137, 512, v137
    ds_read_b128 v[88:91], v137
    ds_read_b128 v[92:95], v137 offset:256
    s_waitcnt lgkmcnt(0)
    v_add_f32 v80, v80, v88
    v_add_f32 v81, v81, v89
    v_add_f32 v82, v82, v90
    v_add_f32 v83, v83, v91
    v_add_f32 v84, v84, v92
    v_add_f32 v85, v85, v93
    v_add_f32 v86, v86, v94
    v_add_f32 v87, v87, v95
    s_branch .L109
.L110:
    s_mov_b64 exec, s[10:11]
.L100:
    s_cmp_eq_u32 s87, 0
    s_cbranch_scc1 .L112
    s_mul_i32 s3, s2, 81920
    s_add_u32 s3, s3, 20971520
    s_add_u32 s72, s38, s3
    s_addc_u32 s73, s39, 0
    s_and_b32 s73, s73, 0xffff
    s_mov_b32 s74, 81920
    s_mov_b32 s75, 0x20000
    v_lshlrev_b32 v139, 5, v0
    s_cmp_eq_u32 s88, 1
    s_cbranch_scc1 .L113
    s_mov_b32 s3, 0
    buffer_load_dwordx4 v[168:171], v139, s[72:75], s3 offen
    buffer_load_dwordx4 v[172:175], v139, s[72:75], s3 offen offset:16
    s_waitcnt vmcnt(0)
    v_add_f32 v48, v48, v168
    v_add_f32 v49, v49, v169
    v_add_f32 v50, v50, v170
    v_add_f32 v51, v51, v171
    v_add_f32 v52, v52, v172
    v_add_f32 v53, v53, v173
    v_add_f32 v54, v54, v174
    v_add_f32 v55, v55, v175
    s_mov_b32 s3, 16384
    buffer_load_dwordx4 v[168:171], v139, s[72:75], s3 offen
    buffer_load_dwordx4 v[172:175], v139, s[72:75], s3 offen offset:16
    s_waitcnt vmcnt(0)
    v_add_f32 v56, v56, v168
    v_add_f32 v57, v57, v169
    v_add_f32 v58, v58, v170
    v_add_f32 v59, v59, v171
    v_add_f32 v60, v60, v172
    v_add_f32 v61, v61, v173
    v_add_f32 v62, v62, v174
    v_add_f32 v63, v63, v175
    s_mov_b32 s3, 32768
    buffer_load_dwordx4 v[168:171], v139, s[72:75], s3 offen
    buffer_load_dwordx4 v[172:175], v139, s[72:75], s3 offen offset:16
    s_waitcnt vmcnt(0)
    v_add_f32 v64, v64, v168
    v_add_f32 v65, v65, v169
    v_add_f32 v66, v66, v170
    v_add_f32 v67, v67, v171
    v_add_f32 v68, v68, v172
    v_add_f32 v69, v69, v173
    v_add_f32 v70, v70, v174
    v_add_f32 v71, v71, v175
    s_mov_b32 s3, 49152
    buffer_load_dwordx4 v[168:171], v139, s[72:75], s3 offen
    buffer_load_dwordx4 v[172:175], v139, s[72:75], s3 offen offset:16
    s_waitcnt vmcnt(0)
    v_add_f32 v72, v72, v168
    v_add_f32 v73, v73, v169
    v_add_f32 v74, v74, v170
    v_add_f32 v75, v75, v171
    v_add_f32 v76, v76, v172
    v_add_f32 v77, v77, v173
    v_add_f32 v78, v78, v174
    v_add_f32 v79, v79, v175
    s_mov_b32 s3, 65536
    buffer_load_dwordx4 v[168:171], v139, s[72:75], s3 offen
    buffer_load_dwordx4 v[172:175], v139, s[72:75], s3 offen offset:16
    s_waitcnt vmcnt(0)
    v_add_f32 v80, v80, v168
    v_add_f32 v81, v81, v169
    v_add_f32 v82, v82, v170
    v_add_f32 v83, v83, v171
    v_add_f32 v84, v84, v172
    v_add_f32 v85, v85, v173
    v_add_f32 v86, v86, v174
    v_add_f32 v87, v87, v175
.L113:
    s_cmp_eq_u32 s89, 1
    s_cbranch_scc1 .L112
    s_mov_b32 s3, 0
    buffer_store_dwordx4 v[48:51], v139, s[72:75], s3 offen
    buffer_store_dwordx4 v[52:55], v139, s[72:75], s3 offen offset:16
    s_mov_b32 s3, 16384
    buffer_store_dwordx4 v[56:59], v139, s[72:75], s3 offen
    buffer_store_dwordx4 v[60:63], v139, s[72:75], s3 offen offset:16
    s_mov_b32 s3, 32768
    buffer_store_dwordx4 v[64:67], v139, s[72:75], s3 offen
    buffer_store_dwordx4 v[68:71], v139, s[72:75], s3 offen offset:16
    s_mov_b32 s3, 49152
    buffer_store_dwordx4 v[72:75], v139, s[72:75], s3 offen
    buffer_store_dwordx4 v[76:79], v139, s[72:75], s3 offen offset:16
    s_mov_b32 s3, 65536
    buffer_store_dwordx4 v[80:83], v139, s[72:75], s3 offen
    buffer_store_dwordx4 v[84:87], v139, s[72:75], s3 offen offset:16
    s_waitcnt vmcnt(0)
    s_branch .L111
.L112:
    s_mov_b32 s8, 0x358637bd
    s_mov_b32 s9, 0x358637bd
    s_mov_b32 s10, 0
    s_mov_b32 s11, 0
    v_add_u32 v141, s99, v15
    v_lshlrev_b32 v141, 9, v141
    v_lshrrev_b32 v139, 1, v138
    s_lshl_b32 s3, s77, 7
    v_add3_u32 v141, v141, v139, s3
    v_mov_b32 v140, 0x80000000
    v_pk_add_f32 v[48:49], v[48:49], s[8:9]
    v_pk_add_f32 v[50:51], v[50:51], s[8:9]
    v_pk_add_f32 v[56:57], v[56:57], s[8:9]
    v_pk_add_f32 v[58:59], v[58:59], s[8:9]
    v_pk_add_f32 v[64:65], v[64:65], s[8:9]
    v_pk_add_f32 v[66:67], v[66:67], s[8:9]
    v_pk_add_f32 v[72:73], v[72:73], s[8:9]
    v_pk_add_f32 v[74:75], v[74:75], s[8:9]
    v_pk_add_f32 v[80:81], v[80:81], s[8:9]
    v_pk_add_f32 v[82:83], v[82:83], s[8:9]
    v_rcp_f32 v48, v48
    v_rcp_f32 v49, v49
    v_rcp_f32 v50, v50
    v_rcp_f32 v51, v51
    v_rcp_f32 v56, v56
    v_rcp_f32 v57, v57
    v_rcp_f32 v58, v58
    v_rcp_f32 v59, v59
    v_rcp_f32 v64, v64
    v_rcp_f32 v65, v65
    v_rcp_f32 v66, v66
    v_rcp_f32 v67, v67
    v_rcp_f32 v72, v72
    v_rcp_f32 v73, v73
    v_rcp_f32 v74, v74
    v_rcp_f32 v75, v75
    v_rcp_f32 v80, v80
    v_rcp_f32 v81, v81
    v_rcp_f32 v82, v82
    v_rcp_f32 v83, v83
    v_pk_fma_f32 v[164:165], v[52:53], v[48:49], v[16:17]
    v_pk_fma_f32 v[166:167], v[54:55], v[50:51], v[18:19]
    v_pk_mul_f32 v[48:49], v[164:165], s[10:11]
    v_pk_mul_f32 v[50:51], v[166:167], s[10:11]
    v_lshlrev_b32 v52, 16, v36
    v_lshlrev_b32 v53, 16, v37
    v_and_b32 v54, 0xffff0000, v36
    v_and_b32 v55, 0xffff0000, v37
    v_max_f32 v164, v164, v48
    v_max_f32 v165, v165, v49
    v_max_f32 v166, v166, v50
    v_max_f32 v167, v167, v51
    v_pk_add_f32 v[164:165], v[164:165], v[52:53]
    v_pk_add_f32 v[166:167], v[166:167], v[54:55]
    v_add_u32 v139, 0, v15
    v_cmp_gt_u32 vcc, s81, v139
    v_cvt_pk_bf16_f32 v142, v164, v166
    v_cvt_pk_bf16_f32 v143, v165, v167
    v_cndmask_b32 v139, v140, v141, vcc
    s_mov_b32 s3, 0
    buffer_store_dwordx2 v[142:143], v139, s[60:63], s3 offen
    v_pk_fma_f32 v[164:165], v[60:61], v[56:57], v[20:21]
    v_pk_fma_f32 v[166:167], v[62:63], v[58:59], v[22:23]
    v_pk_mul_f32 v[56:57], v[164:165], s[10:11]
    v_pk_mul_f32 v[58:59], v[166:167], s[10:11]
    v_lshlrev_b32 v60, 16, v38
    v_lshlrev_b32 v61, 16, v39
    v_and_b32 v62, 0xffff0000, v38
    v_and_b32 v63, 0xffff0000, v39
    v_max_f32 v164, v164, v56
    v_max_f32 v165, v165, v57
    v_max_f32 v166, v166, v58
    v_max_f32 v167, v167, v59
    v_pk_add_f32 v[164:165], v[164:165], v[60:61]
    v_pk_add_f32 v[166:167], v[166:167], v[62:63]
    v_add_u32 v139, 16, v15
    v_cmp_gt_u32 vcc, s81, v139
    v_cvt_pk_bf16_f32 v144, v164, v166
    v_cvt_pk_bf16_f32 v145, v165, v167
    v_cndmask_b32 v139, v140, v141, vcc
    s_mov_b32 s3, 8192
    buffer_store_dwordx2 v[144:145], v139, s[60:63], s3 offen
    v_pk_fma_f32 v[164:165], v[68:69], v[64:65], v[24:25]
    v_pk_fma_f32 v[166:167], v[70:71], v[66:67], v[26:27]
    v_pk_mul_f32 v[64:65], v[164:165], s[10:11]
    v_pk_mul_f32 v[66:67], v[166:167], s[10:11]
    v_lshlrev_b32 v68, 16, v40
    v_lshlrev_b32 v69, 16, v41
    v_and_b32 v70, 0xffff0000, v40
    v_and_b32 v71, 0xffff0000, v41
    v_max_f32 v164, v164, v64
    v_max_f32 v165, v165, v65
    v_max_f32 v166, v166, v66
    v_max_f32 v167, v167, v67
    v_pk_add_f32 v[164:165], v[164:165], v[68:69]
    v_pk_add_f32 v[166:167], v[166:167], v[70:71]
    v_add_u32 v139, 32, v15
    v_cmp_gt_u32 vcc, s81, v139
    v_cvt_pk_bf16_f32 v142, v164, v166
    v_cvt_pk_bf16_f32 v143, v165, v167
    v_cndmask_b32 v139, v140, v141, vcc
    s_mov_b32 s3, 16384
    buffer_store_dwordx2 v[142:143], v139, s[60:63], s3 offen
    v_pk_fma_f32 v[164:165], v[76:77], v[72:73], v[28:29]
    v_pk_fma_f32 v[166:167], v[78:79], v[74:75], v[30:31]
    v_pk_mul_f32 v[72:73], v[164:165], s[10:11]
    v_pk_mul_f32 v[74:75], v[166:167], s[10:11]
    v_lshlrev_b32 v76, 16, v42
    v_lshlrev_b32 v77, 16, v43
    v_and_b32 v78, 0xffff0000, v42
    v_and_b32 v79, 0xffff0000, v43
    v_max_f32 v164, v164, v72
    v_max_f32 v165, v165, v73
    v_max_f32 v166, v166, v74
    v_max_f32 v167, v167, v75
    v_pk_add_f32 v[164:165], v[164:165], v[76:77]
    v_pk_add_f32 v[166:167], v[166:167], v[78:79]
    v_add_u32 v139, 48, v15
    v_cmp_gt_u32 vcc, s81, v139
    v_cvt_pk_bf16_f32 v144, v164, v166
    v_cvt_pk_bf16_f32 v145, v165, v167
    v_cndmask_b32 v139, v140, v141, vcc
    s_mov_b32 s3, 24576
    buffer_store_dwordx2 v[144:145], v139, s[60:63], s3 offen
    v_pk_fma_f32 v[164:165], v[84:85], v[80:81], v[32:33]
    v_pk_fma_f32 v[166:167], v[86:87], v[82:83], v[34:35]
    v_pk_mul_f32 v[80:81], v[164:165], s[10:11]
    v_pk_mul_f32 v[82:83], v[166:167], s[10:11]
    v_lshlrev_b32 v84, 16, v44
    v_lshlrev_b32 v85, 16, v45
    v_and_b32 v86, 0xffff0000, v44
    v_and_b32 v87, 0xffff0000, v45
    v_max_f32 v164, v164, v80
    v_max_f32 v165, v165, v81
    v_max_f32 v166, v166, v82
    v_max_f32 v167, v167, v83
    v_pk_add_f32 v[164:165], v[164:165], v[84:85]
    v_pk_add_f32 v[166:167], v[166:167], v[86:87]
    v_add_u32 v139, 64, v15
    v_cmp_gt_u32 vcc, s81, v139
    v_cvt_pk_bf16_f32 v142, v164, v166
    v_cvt_pk_bf16_f32 v143, v165, v167
    v_cndmask_b32 v139, v140, v141, vcc
    s_mov_b32 s3, 32768
    buffer_store_dwordx2 v[142:143], v139, s[60:63], s3 offen
.L111:
    s_cmp_eq_u32 s89, 1
    s_cbranch_scc1 .Lfin87
    s_mov_b32 s88, 0
    s_add_u32 s85, s85, 1
.Lslow85:
    s_waitcnt vmcnt(0) lgkmcnt(0)
    s_barrier
    v_lshlrev_b32 v4, 4, v0
    v_add_u32 v176, 10000, v1
    v_lshlrev_b32 v176, 8, v176
    v_mov_b32 v177, v176
    v_mov_b32 v178, v176
    v_mov_b32 v179, v176
    v_mov_b32 v180, 0x07fffff8
    v_mov_b32 v181, 0x07fffff8
    v_mov_b32 v182, 0x07fffff8
    v_mov_b32 v183, 0x07fffff8
    v_add_u32 v5, 120064, v4
    ds_write_b128 v5, v[176:179] offset:0
    ds_write_b128 v5, v[176:179] offset:8192
    ds_write_b128 v5, v[180:183] offset:16384
    ds_write_b128 v5, v[180:183] offset:24576
    v_add_u32 v5, 152832, v4
    s_cmp_ge_u32 s78, 6
    s_cbranch_scc1 .L114
    s_lshr_b32 s3, s78, 1
    s_mov_b32 s4, 805318656
    s_cmp_eq_u32 s3, 1
    s_cselect_b32 s4, 167774720, s4
    s_cmp_eq_u32 s3, 2
    s_cselect_b32 s4, 0, s4
    v_mov_b32 v184, s4
    v_mov_b32 v185, s4
    v_mov_b32 v186, s4
    v_mov_b32 v187, s4
    ds_write_b128 v5, v[184:187]
.L114:
    s_cmp_lg_u32 s78, 6
    s_cbranch_scc1 .L115
    v_mov_b32 v176, 0
    v_mov_b32 v177, 0
    v_mov_b32 v178, 0
    v_mov_b32 v179, 0
    v_lshlrev_b32 v5, 4, v1
    v_add_u32 v5, 158976, v5
    v_cmp_gt_u32 vcc, 41, v1
    s_and_saveexec_b64 s[8:9], vcc
    ds_write_b128 v5, v[176:179]
    s_mov_b64 exec, s[8:9]
.L115:
    s_mov_b32 s72, s22
    s_and_b32 s73, s23, 0xffff
    s_mov_b32 s74, 640000
    s_mov_b32 s75, 0x20000
    s_mov_b32 s64, s20
    s_and_b32 s65, s21, 0xffff
    s_mov_b32 s66, 640000
    s_mov_b32 s67, 0x20000
    s_lshl_b32 s3, s85, 11
    v_add_u32 v4, s3, v0
    v_lshlrev_b32 v5, 2, v4
    v_add_u32 v6, 4096, v5
    buffer_load_dword v200, v5, s[72:75], 0 offen offset:0
    buffer_load_dword v201, v5, s[72:75], 0 offen offset:2048
    buffer_load_dword v202, v6, s[72:75], 0 offen offset:0
    buffer_load_dword v203, v6, s[72:75], 0 offen offset:2048
    buffer_load_dword v204, v5, s[64:67], 0 offen offset:0
    buffer_load_dword v205, v5, s[64:67], 0 offen offset:2048
    buffer_load_dword v206, v6, s[64:67], 0 offen offset:0
    buffer_load_dword v207, v6, s[64:67], 0 offen offset:2048
    s_mov_b32 s5, 160000
    s_waitcnt vmcnt(0)
    v_add_u32 v7, 0, v4
    v_subrev_u32 v8, s99, v200
    v_cmp_gt_u32 vcc, s81, v8
    v_cmp_gt_u32 s[8:9], s5, v7
    v_add_u32 v8, 1, v8
    s_and_b64 vcc, vcc, s[8:9]
    v_lshl_or_b32 v8, v204, 8, v8
    v_mov_b32 v80, v7
    v_cndmask_b32 v184, 0, v8, vcc
    v_add_u32 v7, 512, v4
    v_subrev_u32 v8, s99, v201
    v_cmp_gt_u32 vcc, s81, v8
    v_cmp_gt_u32 s[8:9], s5, v7
    v_add_u32 v8, 1, v8
    s_and_b64 vcc, vcc, s[8:9]
    v_lshl_or_b32 v8, v205, 8, v8
    v_mov_b32 v81, v7
    v_cndmask_b32 v185, 0, v8, vcc
    v_add_u32 v7, 1024, v4
    v_subrev_u32 v8, s99, v202
    v_cmp_gt_u32 vcc, s81, v8
    v_cmp_gt_u32 s[8:9], s5, v7
    v_add_u32 v8, 1, v8
    s_and_b64 vcc, vcc, s[8:9]
    v_lshl_or_b32 v8, v206, 8, v8
    v_mov_b32 v82, v7
    v_cndmask_b32 v186, 0, v8, vcc
    v_add_u32 v7, 1536, v4
    v_subrev_u32 v8, s99, v203
    v_cmp_gt_u32 vcc, s81, v8
    v_cmp_gt_u32 s[8:9], s5, v7
    v_add_u32 v8, 1, v8
    s_and_b64 vcc, vcc, s[8:9]
    v_lshl_or_b32 v8, v207, 8, v8
    v_mov_b32 v83, v7
    v_cndmask_b32 v187, 0, v8, vcc
    s_waitcnt vmcnt(0) lgkmcnt(0)
    s_barrier
    v_mov_b32 v11, 1
    s_mov_b32 s3, 158976
    v_and_b32 v216, 0xff, v184
    v_lshl_add_u32 v216, v216, 2, s3
    v_cmpx_ne_u32 vcc, 0, v184
    ds_add_rtn_u32 v200, v216, v11
    s_mov_b64 exec, -1
    v_and_b32 v217, 0xff, v185
    v_lshl_add_u32 v217, v217, 2, s3
    v_cmpx_ne_u32 vcc, 0, v185
    ds_add_rtn_u32 v201, v217, v11
    s_mov_b64 exec, -1
    v_and_b32 v218, 0xff, v186
    v_lshl_add_u32 v218, v218, 2, s3
    v_cmpx_ne_u32 vcc, 0, v186
    ds_add_rtn_u32 v202, v218, v11
    s_mov_b64 exec, -1
    v_and_b32 v219, 0xff, v187
    v_lshl_add_u32 v219, v219, 2, s3
    v_cmpx_ne_u32 vcc, 0, v187
    ds_add_rtn_u32 v203, v219, v11
    s_mov_b64 exec, -1
    s_waitcnt lgkmcnt(0)
    s_barrier
    v_mul_u32_u24 v7, 3, v1
    v_lshlrev_b32 v9, 2, v7
    v_add_u32 v9, 158980, v9
    v_mov_b32 v11, 161600
    ds_read_b32 v4, v9
    ds_read_b32 v5, v9 offset:4
    ds_read_b32 v6, v9 offset:8
    ds_read_b32 v11, v11
    s_waitcnt lgkmcnt(0)
    v_readfirstlane_b32 s90, v11
    v_add_u32 v4, 3, v4
    v_add_u32 v10, 0, v7
    v_lshrrev_b32 v4, 2, v4
    v_cmp_gt_u32 vcc, s81, v10
    v_max_u32 v4, 1, v4
    s_nop 0
    v_cndmask_b32 v4, 0, v4, vcc
    v_add_u32 v5, 3, v5
    v_add_u32 v10, 1, v7
    v_lshrrev_b32 v5, 2, v5
    v_cmp_gt_u32 vcc, s81, v10
    v_max_u32 v5, 1, v5
    s_nop 0
    v_cndmask_b32 v5, 0, v5, vcc
    v_add_u32 v6, 3, v6
    v_add_u32 v10, 2, v7
    v_lshrrev_b32 v6, 2, v6
    v_cmp_gt_u32 vcc, s81, v10
    v_max_u32 v6, 1, v6
    s_nop 0
    v_cndmask_b32 v6, 0, v6, vcc
    v_add3_u32 v8, v4, v5, v6
    v_mov_b32 v10, v8
    s_nop 1
    v_add_u32_dpp v10, v10, v10 row_shr:1 row_mask:0xf bank_mask:0xf bound_ctrl:0
    s_nop 1
    v_add_u32_dpp v10, v10, v10 row_shr:2 row_mask:0xf bank_mask:0xf bound_ctrl:0
    s_nop 1
    v_add_u32_dpp v10, v10, v10 row_shr:4 row_mask:0xf bank_mask:0xf bound_ctrl:0
    s_nop 1
    v_add_u32_dpp v10, v10, v10 row_shr:8 row_mask:0xf bank_mask:0xf bound_ctrl:0
    s_nop 1
    v_add_u32_dpp v10, v10, v10 row_bcast:15 row_mask:0xa bank_mask:0xf
    s_nop 1
    v_add_u32_dpp v10, v10, v10 row_bcast:31 row_mask:0xc bank_mask:0xf
    s_nop 1
    v_readlane_b32 s84, v10, 63
    v_sub_u32 v10, v10, v8
    v_cmp_gt_u32 vcc, 54, v1
    s_add_u32 s82, s84, 31
    s_lshr_b32 s82, s82, 5
    s_and_saveexec_b64 s[8:9], vcc
    v_lshlrev_b32 v9, 2, v7
    v_add_u32 v9, 152832, v9
    s_mov_b32 s3, 120064
    v_mov_b32 v8, 0x10000
    v_lshl_add_u32 v11, v10, 4, s3
    ds_write_b32 v9, v11 offset:6804
    v_cmp_ne_u32 vcc, 0, v4
    v_lshl_or_b32 v11, v4, 16, v10
    v_add_u32 v10, v10, v4
    v_cndmask_b32 v11, v8, v11, vcc
    ds_write_b32 v9, v11 offset:7456
    v_lshl_add_u32 v11, v10, 4, s3
    ds_write_b32 v9, v11 offset:6808
    v_cmp_ne_u32 vcc, 0, v5
    v_lshl_or_b32 v11, v5, 16, v10
    v_add_u32 v10, v10, v5
    v_cndmask_b32 v11, v8, v11, vcc
    ds_write_b32 v9, v11 offset:7460
    v_lshl_add_u32 v11, v10, 4, s3
    ds_write_b32 v9, v11 offset:6812
    v_cmp_ne_u32 vcc, 0, v6
    v_lshl_or_b32 v11, v6, 16, v10
    v_add_u32 v10, v10, v6
    v_cndmask_b32 v11, v8, v11, vcc
    ds_write_b32 v9, v11 offset:7464
    s_mov_b64 exec, s[8:9]
    v_mov_b32 v5, s84
    v_mov_b32 v6, 161604
    ds_write_b32 v6, v5
    v_cvt_f32_u32 v4, s82
    s_nop 0
    v_rcp_f32 v4, v4
    s_waitcnt lgkmcnt(0)
    v_readfirstlane_b32 s83, v4
    ds_read_b32 v96, v216 offset:656
    ds_read_b32 v97, v217 offset:656
    ds_read_b32 v98, v218 offset:656
    ds_read_b32 v99, v219 offset:656
    s_waitcnt lgkmcnt(0)
    v_lshl_add_u32 v96, v200, 2, v96
    v_and_b32 v216, 0x3fff00, v184
    v_cmpx_ne_u32 vcc, 0, v184
    ds_write_b32 v96, v216
    ds_write_b32 v96, v80 offset:16384
    s_mov_b64 exec, -1
    v_lshl_add_u32 v97, v201, 2, v97
    v_and_b32 v217, 0x3fff00, v185
    v_cmpx_ne_u32 vcc, 0, v185
    ds_write_b32 v97, v217
    ds_write_b32 v97, v81 offset:16384
    s_mov_b64 exec, -1
    v_lshl_add_u32 v98, v202, 2, v98
    v_and_b32 v218, 0x3fff00, v186
    v_cmpx_ne_u32 vcc, 0, v186
    ds_write_b32 v98, v218
    ds_write_b32 v98, v82 offset:16384
    s_mov_b64 exec, -1
    v_lshl_add_u32 v99, v203, 2, v99
    v_and_b32 v219, 0x3fff00, v187
    v_cmpx_ne_u32 vcc, 0, v187
    ds_write_b32 v99, v219
    ds_write_b32 v99, v83 offset:16384
    s_mov_b64 exec, -1
    v_mul_u32_u24 v4, 0x5556, v0
    v_lshrrev_b32 v4, 16, v4
    v_mul_u32_u24 v8, 3, v4
    v_sub_u32 v8, v0, v8
    s_mov_b32 s3, 152832
    v_min_u32 v232, 161, v4
    v_lshl_add_u32 v232, v232, 2, s3
    ds_read_b32 v5, v232 offset:7456
    v_cmp_gt_u32 vcc, s81, v4
    v_mul_u32_u24 v234, 17, v4
    v_add_u32 v234, 12288, v234
    v_lshlrev_b32 v235, 4, v4
    s_waitcnt lgkmcnt(0)
    v_and_b32 v6, 0xffff, v5
    v_lshrrev_b32 v7, 16, v5
    v_add3_u32 v9, v6, v7, -1
    v_cndmask_b32 v7, 0, v7, vcc
    v_cvt_f32_u32 v11, v6
    v_add_f32 v11, 0.5, v11
    v_mul_f32 v11, s83, v11
    v_cvt_u32_f32 v11, v11
    v_cvt_f32_u32 v10, v9
    v_add_f32 v10, 0.5, v10
    v_mul_f32 v10, s83, v10
    v_cvt_u32_f32 v10, v10
    v_sub_u32 v10, v10, v11
    v_add_u32 v233, 1, v11
    v_lshl_or_b32 v10, v10, 8, v233
    v_cmp_gt_u32 vcc, 160, v4
    v_mov_b32 v233, 262144
    s_nop 0
    v_cndmask_b32 v232, v233, v232, vcc
    ds_write_b32 v232, v10 offset:8128
    v_add_u32 v9, v6, v8
    v_cvt_f32_u32 v10, v9
    v_add_f32 v10, 0.5, v10
    v_mul_f32 v10, s83, v10
    v_cvt_u32_f32 v10, v10
    v_mul_lo_u32 v5, v10, s82
    v_sub_u32 v5, v9, v5
    s_mov_b64 s[10:11], exec
    s_mov_b32 s4, 2560
.L116:
    v_cmp_lt_u32 vcc, v8, v7
    s_and_b64 exec, exec, vcc
    s_cbranch_execz .L117
    v_lshl_add_u32 v232, v9, 1, s3
    v_lshl_add_u32 v233, v10, 4, s4
    v_cmp_gt_u32 vcc, v10, v11
    v_cmp_ne_u32 s[8:9], 0, v5
    ds_write_b16 v232, v234
    v_cndmask_b32 v233, v235, v233, vcc
    v_cmp_ne_u32 vcc, 0, v8
    ds_write_b16 v232, v233 offset:2048
    s_and_b64 vcc, vcc, s[8:9]
    v_mov_b32 v233, 0x3f80
    v_add_u32 v8, 3, v8
    v_cndmask_b32 v233, 0, v233, vcc
    v_add_u32 v9, 3, v9
    v_add_u32 v5, 3, v5
    ds_write_b16 v232, v233 offset:4096
    v_cmp_le_u32 vcc, s82, v5
    v_subrev_u32 v233, s82, v5
    s_nop 0
    v_cndmask_b32 v5, v5, v233, vcc
    v_cndmask_b32 v233, 0, 1, vcc
    v_add_u32 v10, v10, v233
    s_branch .L116
.L117:
    s_mov_b64 exec, s[10:11]
    s_waitcnt lgkmcnt(0)
    s_cmp_eq_u32 s85, 78
    s_cselect_b32 s89, 1, 0
    s_branch .Lrun86
.Lfin87:
    s_waitcnt vmcnt(0)
.Lexit:
    s_endpgm
.section .rodata,"a"
.p2align 6
.amdhsa_kernel standalone__edge_featured_mpnn_gatedgcn__graph_kernel
  .amdhsa_next_free_vgpr 256
  .amdhsa_next_free_sgpr 102
  .amdhsa_accum_offset 256
  .amdhsa_group_segment_fixed_size 0
  .amdhsa_kernarg_size 96
  .amdhsa_user_sgpr_count 2
  .amdhsa_user_sgpr_kernarg_segment_ptr 1
  .amdhsa_system_sgpr_workgroup_id_x 1
.end_amdhsa_kernel
```
